```python
import torch

def _softmax(x, axis=-1):
    return torch.softmax(x, dim=axis)
def _gelu(x):
    return torch.nn.functional.gelu(x, approximate="tanh")
def _silu(x):
    return torch.nn.functional.silu(x)
def _sigmoid(x):
    return torch.sigmoid(x)
def _layernorm(x, axis=-1, eps=1e-5):
    m = x.mean(dim=axis, keepdim=True)
    v = x.var(dim=axis, keepdim=True, unbiased=False)
    return (x - m) / torch.sqrt(v + eps)
def _scatter_add(tgt, idx, src, axis=0):
    return tgt.clone().index_add_(axis, idx, src)
def _segment_sum(src, seg, n):
    out = torch.zeros((n,) + src.shape[1:], dtype=src.dtype)
    return out.index_add_(0, seg, src)
def _pad(x, pw):
    flat = tuple(v for pair in reversed(pw) for v in pair)
    return torch.nn.functional.pad(x, flat)

kernel_name = 'parallel_sum__linear_kernel_hedgehog__dense_activation_mish__prompt'

def setup_inputs():

    _w = (lambda a: (lambda t: t.to(torch.bfloat16) if t.is_floating_point() else t)(torch.as_tensor(a)))
    def _A_setup():
        B, S, D, H = 1, 2048, 448, 16
        Dh = D // H
        return {
            "x": _w((lambda *s: torch.randn(*s, dtype=torch.bfloat16) * 0.05)(B, S, D)),
            "wqkv": _w((lambda *s: torch.randn(*s, dtype=torch.bfloat16) * 0.2)(D, 3 * D)),
            "w_phi": _w((lambda *s: torch.randn(*s, dtype=torch.bfloat16) * 0.2)(H, Dh, Dh) * (Dh ** -0.5)),
            "wo": _w((lambda *s: torch.randn(*s, dtype=torch.bfloat16) * 0.05)(D, D)),
        }
    _A_in = _A_setup()

    def _B_setup():
        B, S, D, F = 1, 2048, 448, 1792
        return {
            "x": _w((lambda *s: torch.randn(*s, dtype=torch.bfloat16) * 0.05)(B, S, D)),
            "w1": _w((lambda *s: torch.randn(*s, dtype=torch.bfloat16) * 0.8)(D, F) * (D ** -0.5)),
            "b1": _w((lambda *s: torch.randn(*s, dtype=torch.bfloat16) * 0.4)(F)),
            "w2": _w((lambda *s: torch.randn(*s, dtype=torch.bfloat16) * 0.1)(F, D) * (F ** -0.5)),
        }
    _B_in = _B_setup()

    return {
        "A_x": _A_in["x"],
        "A_wqkv": _A_in["wqkv"],
        "A_w_phi": _A_in["w_phi"],
        "A_wo": _A_in["wo"],
        "B_x": _B_in["x"],
        "B_w1": _B_in["w1"],
        "B_b1": _B_in["b1"],
        "B_w2": _B_in["w2"],
    }

def reference(A_x, A_wqkv, A_w_phi, A_wo, B_x, B_w1, B_b1, B_w2):
    def _A_ref(x, wqkv, w_phi, wo):
        B, S, D = x.shape
        H = 16; Dh = D // H
        qkv = (lambda x, *d: x.permute(*d))((x @ wqkv).reshape(B, S, 3, H, Dh), 2, 0, 3, 1, 4)
        q, k, v = qkv[0], qkv[1], qkv[2]
        pq = torch.einsum("bhsd,hdf->bhsf", q, w_phi)
        pk = torch.einsum("bhsd,hdf->bhsf", k, w_phi)
        phi_q = torch.concatenate([_softmax(pq, axis=-1), _softmax(-pq, axis=-1)], axis=-1)
        phi_k = torch.concatenate([_softmax(pk, axis=-1), _softmax(-pk, axis=-1)], axis=-1)
        kv = torch.einsum("bhsf,bhsd->bhfd", phi_k, v)
        z  = torch.einsum("bhsf->bhf", phi_k)
        num = torch.einsum("bhqf,bhfd->bhqd", phi_q, kv)
        den = torch.einsum("bhqf,bhf->bhq", phi_q, z)[..., None] + 1e-6
        o = num / den
        return (lambda x, *d: x.permute(*d))(o, 0, 2, 1, 3).reshape(B, S, D) @ wo

    def _B_ref(x, w1, b1, w2):
        h = torch.einsum("bsd,df->bsf", x, w1) + b1
        sp = torch.log1p(torch.exp(-torch.abs(h))) + torch.where(h > 0, h, torch.zeros_like(h))
        act = h * torch.tanh(sp)
        return torch.einsum("bsf,fd->bsd", act, w2)

    x = A_x
    xn = _layernorm(x, axis=-1)
    return x + _A_ref(xn, A_wqkv, A_w_phi, A_wo) + _B_ref(xn, B_w1, B_b1, B_w2)
```

```asm
; @launch grid=(256,1,1) block=(512,1,1) lds=163840
.amdgcn_target "amdgcn-amd-amdhsa--gfx950"
.text
.globl parallel_sum__linear_kernel_hedgehog__dense_activation_mish__prompt_kernel
.p2align 8
.type parallel_sum__linear_kernel_hedgehog__dense_activation_mish__prompt_kernel,@function
parallel_sum__linear_kernel_hedgehog__dense_activation_mish__prompt_kernel:
	s_load_dwordx8 s[52:59], s[0:1], 0
	s_load_dwordx8 s[60:67], s[0:1], 40
	s_load_dwordx4 s[96:99], s[0:1], 72
	s_cmp_ge_u32 s2, 256
	s_cbranch_scc1 parallel_sum__linear_kernel_hedgehog__dense_activation_mish__prompt_kernel_end
	v_lshrrev_b32 v225, 6, v0
	v_and_b32 v0, 63, v0
	v_readfirstlane_b32 s24, v225
	s_getpc_b64 s[34:35]
parallel_sum__linear_kernel_hedgehog__dense_activation_mish__prompt_kernel_pc1:
	s_lshr_b32 s32, s2, 3
	s_lshl_b32 s32, s32, 3
	s_add_u32 s32, s32, s24
	s_lshl_b32 s32, s32, 7
	s_min_u32 s32, s32, parallel_sum__linear_kernel_hedgehog__dense_activation_mish__prompt_kernel_last-parallel_sum__linear_kernel_hedgehog__dense_activation_mish__prompt_kernel_pc1
	v_mov_b32 v226, s32
	global_load_dword v230, v226, s[34:35]
	s_lshr_b32 s33, s2, 3
	s_and_b32 s34, s2, 1
	s_lshl_b32 s34, s34, 3
	s_and_b32 s35, s33, 7
	s_add_u32 s27, s34, s35
	s_and_b32 s34, s2, 2
	s_lshl_b32 s34, s34, 1
	s_lshr_b32 s35, s33, 3
	s_add_u32 s28, s34, s35
	s_mul_i32 s31, s27, 114688
	s_lshl_b32 s29, s24, 11
	s_lshl_b32 s30, s24, 10
	v_lshrrev_b32 v225, 3, v0
	v_and_b32 v226, 7, v0
	v_lshrrev_b32 v227, 4, v0
	v_xor_b32 v228, v226, v227
	v_lshlrev_b32 v228, 4, v228
	s_lshl_b32 s32, s24, 4
	v_add_u32 v205, s32, v225
	s_movk_i32 s33, 896
	v_mad_u32_u24 v204, v205, s33, v228
	v_xor_b32 v205, 64, v204
	v_add_u32 v205, 7168, v205
	v_lshlrev_b32 v227, 2, v227
	v_and_b32 v227, 4, v227
	v_xor_b32 v226, v226, v227
	s_lshl_b32 s32, s24, 3
	v_add_u32 v225, s32, v225
	s_mul_i32 s34, s28, 7
	s_and_b32 s35, s28, 1
	s_add_u32 s34, s34, s35
	s_lshl_b32 s34, s34, 6
	s_lshr_b32 s35, s28, 1
	s_lshr_b32 s32, s28, 2
	s_and_b32 s35, s35, s32
	s_and_b32 s35, s35, 1
	s_xor_b32 s35, s28, s35
	s_mul_i32 s32, s35, 112
	s_add_u32 s32, s32, 896
	s_movk_i32 s33, 0xe00
	s_movk_i32 s93, 0xa80
	s_bitcmp1_b32 s2, 2
	s_cselect_b32 s36, s34, s32
	s_cselect_b32 s28, s28, s35
	s_cselect_b32 s3, s33, s93
	s_cselect_b32 s32, 8, 7
	s_waitcnt lgkmcnt(0)
	s_cselect_b32 s12, s60, s54
	s_cselect_b32 s13, s61, s55
	v_lshlrev_b32 v227, 4, v226
	v_mad_u32_u24 v1, v225, s3, v227
	v_cmp_eq_u32 vcc, s32, v226
	v_mov_b32 v227, 0x40000000
	s_nop 0
	v_cndmask_b32 v1, v1, v227, vcc
	s_lshl_b32 s93, s3, 6
	s_mul_i32 s33, s3, 448
	s_mov_b32 s8, s52
	s_and_b32 s9, s53, 0xffff
	s_mov_b32 s10, 0x1c0000
	s_mov_b32 s11, 0x00020000
	s_and_b32 s13, s13, 0xffff
	s_mov_b32 s14, s33
	s_mov_b32 s15, 0x00020000
	s_add_u32 m0, s29, 0
	s_nop 0
	buffer_load_dwordx4 v204, s[8:11], s31 offen offset:0 lds
	s_add_u32 m0, s29, 1024
	s_nop 0
	buffer_load_dwordx4 v205, s[8:11], s31 offen offset:0 lds
	s_add_u32 m0, s30, 114688
	s_nop 0
	buffer_load_dwordx4 v1, s[12:15], s36 offen lds
	s_add_u32 s36, s36, s93
	s_bitcmp1_b32 s2, 2
	s_nop 0
	s_cbranch_scc1 parallel_sum__linear_kernel_hedgehog__dense_activation_mish__prompt_kernel_ffn
	s_mov_b32 s20, s56
	s_and_b32 s21, s57, 0xffff
	s_mov_b32 s22, 0x6200
	s_mov_b32 s23, 0x00020000
	s_mov_b32 s16, s98
	s_and_b32 s17, s99, 0xffff
	s_mov_b32 s18, 0xb00000
	s_mov_b32 s19, 0x00020000
	s_mov_b32 s68, s64
	s_and_b32 s69, s65, 0xffff
	s_mov_b32 s70, 0x188000
	s_mov_b32 s71, 0x00020000
	s_mov_b32 s72, s58
	s_and_b32 s73, s59, 0xffff
	s_mov_b32 s74, 0x62000
	s_mov_b32 s75, 0x00020000
	s_mov_b32 s76, s66
	s_and_b32 s77, s67, 0xffff
	s_mov_b32 s78, 0x1c0000
	s_mov_b32 s79, 0x00020000
	s_and_b32 s25, s24, 3
	s_lshr_b32 s26, s24, 2
	s_lshl_b32 s50, s26, 1
	s_xor_b32 s50, s50, s25
	v_lshrrev_b32 v225, 5, v0
	s_lshl_b32 s33, s50, 1
	v_add_u32 v226, s33, v225
	v_bfe_u32 v227, v0, 1, 3
	v_xor_b32 v226, v226, v227
	v_lshlrev_b32 v226, 4, v226
	v_and_b32 v227, 31, v0
	v_lshl_add_u32 v226, v227, 7, v226
	s_lshl_b32 s33, s25, 12
	v_add_u32 v200, s33, v226
	v_xor_b32 v201, 32, v200
	v_xor_b32 v202, 64, v200
	v_xor_b32 v203, 96, v200
	v_lshlrev_b32 v2, 4, v0
	v_lshlrev_b32 v232, 2, v0
	v_lshlrev_b32 v231, 7, v0
	s_lshl_b32 s33, s26, 10
	s_add_u32 s33, s33, 155648
	v_add_u32 v224, s33, v2
	s_lshl_b32 s33, s25, 2
	v_add_u32 v223, s33, v224
	s_lshl_b32 s33, s25, 10
	s_add_u32 s33, s33, 159744
	v_lshlrev_b32 v227, 5, v227
	v_add_u32 v207, s33, v227
	s_lshl_b32 s33, s26, 4
	v_lshl_add_u32 v206, v225, 3, v207
	v_add_u32 v206, s33, v206
	v_mov_b32 v216, 0x3f803f80
	v_mov_b32 v217, 0x3f803f80
	v_mov_b32 v187, 0
	s_mov_b32 s42, 0x22222222
	s_mov_b32 s43, 0x22222222
	s_mov_b32 s44, 0xcccccccc
	s_mov_b32 s45, 0xcccccccc
	s_mov_b32 s46, 0x88888888
	s_mov_b32 s47, 0x88888888
	s_mov_b32 s48, 0
	s_mov_b32 s49, -1
	s_mov_b32 s51, 0x3b124925
	s_mul_i32 s38, s28, 112
	s_add_u32 s37, s38, 1792
	v_and_b32 v227, 3, v0
	v_lshlrev_b32 v227, 3, v227
	v_bfe_u32 v228, v0, 4, 1
	v_lshl_add_u32 v227, v228, 5, v227
	s_mul_i32 s32, s26, 56
	v_add_u32 v3, s32, v227
	v_cmp_eq_u32 vcc, 56, v227
	v_mov_b32 v228, 112
	s_nop 0
	v_cndmask_b32 v3, v3, v228, vcc
	v_lshrrev_b32 v225, 5, v0
	v_lshlrev_b32 v225, 10, v225
	v_bfe_u32 v226, v0, 2, 2
	v_lshl_add_u32 v225, v226, 7, v225
	v_lshlrev_b32 v226, 3, v0
	v_and_b32 v226, 64, v226
	v_xor_b32 v226, v226, v3
	v_add_u32 v225, v225, v226
	s_lshl_b32 s33, s50, 11
	s_add_u32 s33, s33, 114688
	v_add_u32 v218, s33, v225
	v_xor_b32 v219, 2048, v218
	v_xor_b32 v220, 4096, v218
	v_xor_b32 v221, 6144, v218
	s_mul_i32 s39, s28, 3136
	s_lshl_b32 s34, s25, 10
	s_add_u32 s39, s39, s34
	s_add_u32 s41, s34, 147456
	s_add_u32 m0, s29, 16256
	s_nop 0
	buffer_load_dwordx4 v204, s[8:11], s31 offen offset:128 lds
	s_add_u32 m0, s29, 17280
	s_nop 0
	buffer_load_dwordx4 v205, s[8:11], s31 offen offset:128 lds
	s_add_u32 m0, s30, 122880
	s_nop 0
	buffer_load_dwordx4 v1, s[12:15], s36 offen lds
	s_add_u32 s36, s36, s93
	s_add_u32 m0, s29, 32512
	s_nop 0
	buffer_load_dwordx4 v204, s[8:11], s31 offen offset:256 lds
	s_add_u32 m0, s29, 33536
	s_nop 0
	buffer_load_dwordx4 v205, s[8:11], s31 offen offset:256 lds
	s_add_u32 m0, s30, 147456
	s_nop 0
	buffer_load_dwordx4 v1, s[12:15], s36 offen lds
	s_add_u32 s36, s36, s93
	s_add_u32 m0, s29, 48768
	s_nop 0
	buffer_load_dwordx4 v204, s[8:11], s31 offen offset:384 lds
	s_add_u32 m0, s29, 49792
	s_nop 0
	buffer_load_dwordx4 v205, s[8:11], s31 offen offset:384 lds
	s_add_u32 m0, s30, 131072
	s_nop 0
	buffer_load_dwordx4 v1, s[12:15], s36 offen lds
	s_add_u32 s36, s36, s93
	s_nop 0
	s_or_b32 s32, s2, s24
	s_cbranch_scc1 parallel_sum__linear_kernel_hedgehog__dense_activation_mish__prompt_kernel_tw2
	s_memrealtime s[34:35]
	v_mov_b32 v228, 0
	s_waitcnt lgkmcnt(0)
	s_or_b32 s34, s34, 1
	v_mov_b32 v229, s34
	s_mov_b64 exec, 1
	global_store_dword v228, v229, s[96:97] sc1
	s_mov_b64 exec, -1
	s_nop 1
parallel_sum__linear_kernel_hedgehog__dense_activation_mish__prompt_kernel_tw2:
	v_and_b32 v248, 3, v0
	v_lshlrev_b32 v248, 3, v248
	v_bfe_u32 v246, v0, 4, 1
	v_lshl_add_u32 v248, v246, 5, v248
	v_min_u32 v248, 48, v248
	v_lshrrev_b32 v246, 5, v0
	v_bfe_u32 v247, v0, 2, 2
	v_lshl_add_u32 v246, v246, 2, v247
	v_mad_u32_u24 v3, v246, 56, v248
	s_mul_i32 s32, s26, 1568
	s_add_u32 s32, s32, 147456
	v_add_u32 v3, s32, v3
	v_and_b32 v246, 31, v0
	v_lshrrev_b32 v247, 5, v0
	v_lshlrev_b32 v247, 2, v247
	v_sub_u32 v247, v246, v247
	v_lshlrev_b32 v247, 4, v247
	s_movk_i32 s32, 0x3f80
	v_subrev_u32 v248, 0, v247
	v_lshlrev_b32 v236, v248, s32
	v_cmp_gt_u32 vcc, 32, v248
	s_nop 1
	v_cndmask_b32 v236, 0, v236, vcc
	v_subrev_u32 v248, 32, v247
	v_lshlrev_b32 v237, v248, s32
	v_cmp_gt_u32 vcc, 32, v248
	s_nop 1
	v_cndmask_b32 v237, 0, v237, vcc
	v_subrev_u32 v248, 128, v247
	v_lshlrev_b32 v238, v248, s32
	v_cmp_gt_u32 vcc, 32, v248
	s_nop 1
	v_cndmask_b32 v238, 0, v238, vcc
	v_subrev_u32 v248, 160, v247
	v_lshlrev_b32 v239, v248, s32
	v_cmp_gt_u32 vcc, 32, v248
	s_nop 1
	v_cndmask_b32 v239, 0, v239, vcc
	v_subrev_u32 v248, 256, v247
	v_lshlrev_b32 v240, v248, s32
	v_cmp_gt_u32 vcc, 32, v248
	s_nop 1
	v_cndmask_b32 v240, 0, v240, vcc
	v_subrev_u32 v248, 288, v247
	v_lshlrev_b32 v241, v248, s32
	v_cmp_gt_u32 vcc, 32, v248
	s_nop 1
	v_cndmask_b32 v241, 0, v241, vcc
	v_subrev_u32 v248, 384, v247
	v_lshlrev_b32 v242, v248, s32
	v_cmp_gt_u32 vcc, 32, v248
	s_nop 1
	v_cndmask_b32 v242, 0, v242, vcc
	v_subrev_u32 v248, 416, v247
	v_lshlrev_b32 v243, v248, s32
	v_cmp_gt_u32 vcc, 32, v248
	s_nop 1
	v_cndmask_b32 v243, 0, v243, vcc
	v_and_b32 v248, 1, v0
	v_lshlrev_b32 v248, 4, v248
	v_lshlrev_b32 v248, v248, s32
	v_cndmask_b32 v244, v248, 0, s[44:45]
	v_cndmask_b32 v245, 0, v248, s[44:45]
	v_cmp_eq_u32 vcc, 28, v246
	s_nop 1
	v_cndmask_b32 v252, 0, 1.0, vcc
	v_cmp_eq_u32 vcc, 29, v246
	v_mov_b32 v248, 0x3f80
	s_nop 0
	v_cndmask_b32 v253, 0, v248, vcc
	v_cmp_eq_u32 s[60:61], 30, v246
	s_lshl_b32 s33, s27, 2
	s_add_u32 s33, s33, s25
	s_lshl_b32 s101, s33, 12
	s_mul_i32 s33, s33, 144
	s_lshl_b32 s34, s28, 1
	s_add_u32 s34, s34, s26
	s_lshl_b32 s35, s34, 7
	s_add_u32 s101, s101, s35
	s_lshl_b32 s35, s34, 1
	s_add_u32 s40, s33, s35
	s_add_u32 s40, s40, 2160
	s_lshl_b32 s40, s40, 10
	s_lshl_b32 s56, s28, 17
	s_lshl_b32 s34, s24, 10
	s_add_u32 s56, s56, s34
	s_add_u32 s56, s56, 0x80000
	s_lshl_b32 s34, s27, 13
	s_add_u32 s57, s56, s34
	s_lshl_b32 s34, s28, 11
	s_add_u32 s59, s34, 0x40000
	s_lshl_b32 s34, s27, 7
	s_add_u32 s58, s59, s34
	s_lshl_b32 s34, 1, s27
	s_xor_b32 s52, s34, 0xffff
	s_cmp_eq_u32 s24, 0
	s_cselect_b32 s95, 0, 0x40000000
	s_waitcnt vmcnt(9)
	s_barrier
	ds_read_b128 v[4:7], v200 offset:0
	ds_read_b64_tr_b16 v[148:149], v218 offset:0
	ds_read_b64_tr_b16 v[150:151], v218 offset:512
	s_add_u32 m0, s29, 65024
	s_nop 0
	buffer_load_dwordx4 v204, s[8:11], s31 offen offset:512 lds
	ds_read_b128 v[8:11], v201 offset:0
	ds_read_b64_tr_b16 v[152:153], v219 offset:0
	ds_read_b64_tr_b16 v[154:155], v219 offset:512
	s_add_u32 m0, s29, 66048
	s_nop 0
	buffer_load_dwordx4 v205, s[8:11], s31 offen offset:512 lds
	ds_read_b128 v[60:63], v202 offset:0
	ds_read_b64_tr_b16 v[156:157], v220 offset:0
	ds_read_b64_tr_b16 v[158:159], v220 offset:512
	s_add_u32 m0, s30, 139264
	s_nop 0
	buffer_load_dwordx4 v1, s[12:15], s36 offen lds
	s_add_u32 s36, s36, s93
	ds_read_b128 v[64:67], v203 offset:0
	ds_read_b64_tr_b16 v[160:161], v221 offset:0
	ds_read_b64_tr_b16 v[162:163], v221 offset:512
	s_waitcnt vmcnt(9)
	s_barrier
	s_waitcnt lgkmcnt(9)
	v_mfma_f32_32x32x16_bf16 v[116:131], v[148:151], v[4:7], 0
	ds_read_b128 v[12:15], v200 offset:16384
	ds_read_b64_tr_b16 v[164:165], v218 offset:8192
	ds_read_b64_tr_b16 v[166:167], v218 offset:8704
	s_add_u32 m0, s29, 81280
	s_nop 0
	buffer_load_dwordx4 v204, s[8:11], s31 offen offset:640 lds
	v_mfma_f32_4x4x4_16b_bf16 v[180:183], v[216:217], v[148:149], 0
	v_mfma_f32_4x4x4_16b_bf16 v[192:195], v[216:217], v[4:5], 0
	v_mfma_f32_4x4x4_16b_bf16 v[196:199], v[4:5], v[4:5], 0
	s_waitcnt lgkmcnt(9)
	v_mfma_f32_32x32x16_bf16 v[116:131], v[152:155], v[8:11], v[116:131]
	ds_read_b128 v[16:19], v201 offset:16384
	ds_read_b64_tr_b16 v[168:169], v219 offset:8192
	ds_read_b64_tr_b16 v[170:171], v219 offset:8704
	s_add_u32 m0, s29, 82304
	s_nop 0
	buffer_load_dwordx4 v205, s[8:11], s31 offen offset:640 lds
	v_mfma_f32_4x4x4_16b_bf16 v[180:183], v[216:217], v[150:151], v[180:183]
	v_mfma_f32_4x4x4_16b_bf16 v[192:195], v[216:217], v[8:9], v[192:195]
	v_mfma_f32_4x4x4_16b_bf16 v[196:199], v[8:9], v[8:9], v[196:199]
	s_waitcnt lgkmcnt(9)
	v_mfma_f32_32x32x16_bf16 v[116:131], v[156:159], v[60:63], v[116:131]
	ds_read_b128 v[68:71], v202 offset:16384
	ds_read_b64_tr_b16 v[172:173], v220 offset:8192
	ds_read_b64_tr_b16 v[174:175], v220 offset:8704
	v_mfma_f32_4x4x4_16b_bf16 v[192:195], v[216:217], v[6:7], v[192:195]
	v_mfma_f32_4x4x4_16b_bf16 v[196:199], v[6:7], v[6:7], v[196:199]
	s_waitcnt lgkmcnt(9)
	v_mfma_f32_32x32x16_bf16 v[116:131], v[160:163], v[64:67], v[116:131]
	ds_read_b128 v[72:75], v203 offset:16384
	ds_read_b64_tr_b16 v[176:177], v221 offset:8192
	ds_read_b64_tr_b16 v[178:179], v221 offset:8704
	v_mfma_f32_4x4x4_16b_bf16 v[192:195], v[216:217], v[10:11], v[192:195]
	v_mfma_f32_4x4x4_16b_bf16 v[196:199], v[10:11], v[10:11], v[196:199]
	s_waitcnt vmcnt(8)
	s_barrier
	s_waitcnt lgkmcnt(9)
	v_mfma_f32_32x32x16_bf16 v[116:131], v[164:167], v[12:15], v[116:131]
	ds_read_b128 v[20:23], v200 offset:32768
	ds_read_b64_tr_b16 v[148:149], v218 offset:32768
	ds_read_b64_tr_b16 v[150:151], v218 offset:33280
	s_add_u32 m0, s30, 114688
	s_nop 0
	buffer_load_dwordx4 v1, s[12:15], s36 offen lds
	s_add_u32 s36, s36, s93
	v_mfma_f32_4x4x4_16b_bf16 v[180:183], v[216:217], v[164:165], v[180:183]
	v_mfma_f32_4x4x4_16b_bf16 v[192:195], v[216:217], v[12:13], v[192:195]
	v_mfma_f32_4x4x4_16b_bf16 v[196:199], v[12:13], v[12:13], v[196:199]
	s_waitcnt lgkmcnt(9)
	v_mfma_f32_32x32x16_bf16 v[116:131], v[168:171], v[16:19], v[116:131]
	ds_read_b128 v[24:27], v201 offset:32768
	ds_read_b64_tr_b16 v[152:153], v219 offset:32768
	ds_read_b64_tr_b16 v[154:155], v219 offset:33280
	s_add_u32 m0, s29, 97536
	s_nop 0
	buffer_load_dwordx4 v204, s[8:11], s31 offen offset:768 lds
	v_mfma_f32_4x4x4_16b_bf16 v[180:183], v[216:217], v[166:167], v[180:183]
	v_mfma_f32_4x4x4_16b_bf16 v[192:195], v[216:217], v[16:17], v[192:195]
	v_mfma_f32_4x4x4_16b_bf16 v[196:199], v[16:17], v[16:17], v[196:199]
	s_waitcnt lgkmcnt(9)
	v_mfma_f32_32x32x16_bf16 v[116:131], v[172:175], v[68:71], v[116:131]
	ds_read_b128 v[76:79], v202 offset:32768
	ds_read_b64_tr_b16 v[156:157], v220 offset:32768
	ds_read_b64_tr_b16 v[158:159], v220 offset:33280
	s_add_u32 m0, s29, 98560
	s_nop 0
	buffer_load_dwordx4 v205, s[8:11], s31 offen offset:768 lds
	v_mov_b32 v229, 0
	global_load_dword v229, v229, s[96:97] sc1
	v_mfma_f32_4x4x4_16b_bf16 v[192:195], v[216:217], v[14:15], v[192:195]
	v_mfma_f32_4x4x4_16b_bf16 v[196:199], v[14:15], v[14:15], v[196:199]
	s_waitcnt lgkmcnt(9)
	v_mfma_f32_32x32x16_bf16 v[116:131], v[176:179], v[72:75], v[116:131]
	ds_read_b128 v[80:83], v203 offset:32768
	ds_read_b64_tr_b16 v[160:161], v221 offset:32768
	ds_read_b64_tr_b16 v[162:163], v221 offset:33280
	v_mfma_f32_4x4x4_16b_bf16 v[192:195], v[216:217], v[18:19], v[192:195]
	v_mfma_f32_4x4x4_16b_bf16 v[196:199], v[18:19], v[18:19], v[196:199]
	s_waitcnt vmcnt(9)
	s_barrier
	s_waitcnt lgkmcnt(9)
	v_mfma_f32_32x32x16_bf16 v[116:131], v[148:151], v[20:23], v[116:131]
	ds_read_b128 v[28:31], v200 offset:49152
	ds_read_b64_tr_b16 v[164:165], v218 offset:16384
	ds_read_b64_tr_b16 v[166:167], v218 offset:16896
	s_add_u32 m0, s30, 122880
	s_nop 0
	buffer_load_dwordx4 v1, s[12:15], s36 offen lds
	s_add_u32 s36, s36, s93
	v_mfma_f32_4x4x4_16b_bf16 v[180:183], v[216:217], v[148:149], v[180:183]
	v_mfma_f32_4x4x4_16b_bf16 v[192:195], v[216:217], v[20:21], v[192:195]
	v_mfma_f32_4x4x4_16b_bf16 v[196:199], v[20:21], v[20:21], v[196:199]
	s_waitcnt lgkmcnt(9)
	v_mfma_f32_32x32x16_bf16 v[116:131], v[152:155], v[24:27], v[116:131]
	ds_read_b128 v[32:35], v201 offset:49152
	ds_read_b64_tr_b16 v[168:169], v219 offset:16384
	ds_read_b64_tr_b16 v[170:171], v219 offset:16896
	s_add_u32 m0, s30, 0
	s_nop 0
	buffer_load_dwordx4 v1, s[12:15], s37 offen lds
	s_add_u32 s37, s37, s93
	v_mfma_f32_4x4x4_16b_bf16 v[180:183], v[216:217], v[150:151], v[180:183]
	v_mfma_f32_4x4x4_16b_bf16 v[192:195], v[216:217], v[24:25], v[192:195]
	v_mfma_f32_4x4x4_16b_bf16 v[196:199], v[24:25], v[24:25], v[196:199]
	v_add_u32 v200, 0x10000, v200
	s_waitcnt lgkmcnt(9)
	v_mfma_f32_32x32x16_bf16 v[116:131], v[156:159], v[76:79], v[116:131]
	ds_read_b128 v[84:87], v202 offset:49152
	ds_read_b64_tr_b16 v[172:173], v220 offset:16384
	ds_read_b64_tr_b16 v[174:175], v220 offset:16896
	s_add_u32 m0, s30, 8192
	s_nop 0
	buffer_load_dwordx4 v1, s[12:15], s37 offen lds
	s_add_u32 s37, s37, s93
	v_mfma_f32_4x4x4_16b_bf16 v[192:195], v[216:217], v[22:23], v[192:195]
	v_mfma_f32_4x4x4_16b_bf16 v[196:199], v[22:23], v[22:23], v[196:199]
	v_add_u32 v201, 0x10000, v201
	s_waitcnt lgkmcnt(9)
	v_mfma_f32_32x32x16_bf16 v[116:131], v[160:163], v[80:83], v[116:131]
	ds_read_b128 v[88:91], v203 offset:49152
	ds_read_b64_tr_b16 v[176:177], v221 offset:16384
	ds_read_b64_tr_b16 v[178:179], v221 offset:16896
	v_mfma_f32_4x4x4_16b_bf16 v[192:195], v[216:217], v[26:27], v[192:195]
	v_mfma_f32_4x4x4_16b_bf16 v[196:199], v[26:27], v[26:27], v[196:199]
	v_add_u32 v202, 0x10000, v202
	s_waitcnt vmcnt(9)
	s_barrier
	s_waitcnt lgkmcnt(9)
	v_mfma_f32_32x32x16_bf16 v[116:131], v[164:167], v[28:31], v[116:131]
	ds_read_b128 v[36:39], v200 offset:0
	ds_read_b64_tr_b16 v[148:149], v218 offset:24576
	ds_read_b64_tr_b16 v[150:151], v218 offset:25088
	s_add_u32 m0, s30, 16384
	s_nop 0
	buffer_load_dwordx4 v1, s[12:15], s37 offen lds
	s_add_u32 s37, s37, s93
	v_mfma_f32_4x4x4_16b_bf16 v[180:183], v[216:217], v[164:165], v[180:183]
	v_mfma_f32_4x4x4_16b_bf16 v[192:195], v[216:217], v[28:29], v[192:195]
	v_mfma_f32_4x4x4_16b_bf16 v[196:199], v[28:29], v[28:29], v[196:199]
	v_add_u32 v203, 0x10000, v203
	s_waitcnt lgkmcnt(9)
	v_mfma_f32_32x32x16_bf16 v[116:131], v[168:171], v[32:35], v[116:131]
	ds_read_b128 v[40:43], v201 offset:0
	ds_read_b64_tr_b16 v[152:153], v219 offset:24576
	ds_read_b64_tr_b16 v[154:155], v219 offset:25088
	s_mov_b32 m0, s41
	s_nop 0
	buffer_load_dwordx4 v2, s[20:23], s39 offen lds
	v_mfma_f32_4x4x4_16b_bf16 v[180:183], v[216:217], v[166:167], v[180:183]
	v_mfma_f32_4x4x4_16b_bf16 v[192:195], v[216:217], v[32:33], v[192:195]
	v_mfma_f32_4x4x4_16b_bf16 v[196:199], v[32:33], v[32:33], v[196:199]
	s_waitcnt lgkmcnt(9)
	v_mfma_f32_32x32x16_bf16 v[116:131], v[172:175], v[84:87], v[116:131]
	ds_read_b128 v[92:95], v202 offset:0
	ds_read_b64_tr_b16 v[156:157], v220 offset:24576
	ds_read_b64_tr_b16 v[158:159], v220 offset:25088
	s_add_u32 m0, s30, 24576
	s_nop 0
	buffer_load_dwordx4 v1, s[12:15], s37 offen lds
	s_add_u32 s37, s37, s93
	v_mfma_f32_4x4x4_16b_bf16 v[192:195], v[216:217], v[30:31], v[192:195]
	v_mfma_f32_4x4x4_16b_bf16 v[196:199], v[30:31], v[30:31], v[196:199]
	s_waitcnt lgkmcnt(9)
	v_mfma_f32_32x32x16_bf16 v[116:131], v[176:179], v[88:91], v[116:131]
	ds_read_b128 v[96:99], v203 offset:0
	ds_read_b64_tr_b16 v[160:161], v221 offset:24576
	ds_read_b64_tr_b16 v[162:163], v221 offset:25088
	v_mfma_f32_4x4x4_16b_bf16 v[192:195], v[216:217], v[34:35], v[192:195]
	v_mfma_f32_4x4x4_16b_bf16 v[196:199], v[34:35], v[34:35], v[196:199]
	s_waitcnt vmcnt(9)
	s_barrier
	s_waitcnt lgkmcnt(9)
	v_mfma_f32_32x32x16_bf16 v[116:131], v[148:151], v[36:39], v[116:131]
	ds_read_b128 v[44:47], v200 offset:16384
	ds_read_b64_tr_b16 v[164:165], v218 offset:0
	ds_read_b64_tr_b16 v[166:167], v218 offset:512
	s_add_u32 m0, s30, 32768
	s_nop 0
	buffer_load_dwordx4 v1, s[12:15], s37 offen lds
	s_add_u32 s37, s37, s93
	v_mfma_f32_4x4x4_16b_bf16 v[180:183], v[216:217], v[148:149], v[180:183]
	v_mfma_f32_4x4x4_16b_bf16 v[192:195], v[216:217], v[36:37], v[192:195]
	v_mfma_f32_4x4x4_16b_bf16 v[196:199], v[36:37], v[36:37], v[196:199]
	s_waitcnt lgkmcnt(9)
	v_mfma_f32_32x32x16_bf16 v[116:131], v[152:155], v[40:43], v[116:131]
	ds_read_b128 v[48:51], v201 offset:16384
	ds_read_b64_tr_b16 v[168:169], v219 offset:0
	ds_read_b64_tr_b16 v[170:171], v219 offset:512
	v_mfma_f32_4x4x4_16b_bf16 v[180:183], v[216:217], v[150:151], v[180:183]
	v_mfma_f32_4x4x4_16b_bf16 v[192:195], v[216:217], v[40:41], v[192:195]
	v_mfma_f32_4x4x4_16b_bf16 v[196:199], v[40:41], v[40:41], v[196:199]
	s_waitcnt lgkmcnt(9)
	v_mfma_f32_32x32x16_bf16 v[116:131], v[156:159], v[92:95], v[116:131]
	ds_read_b128 v[100:103], v202 offset:16384
	ds_read_b64_tr_b16 v[172:173], v220 offset:0
	ds_read_b64_tr_b16 v[174:175], v220 offset:512
	s_add_u32 m0, s30, 40960
	s_nop 0
	buffer_load_dwordx4 v1, s[12:15], s37 offen lds
	s_add_u32 s37, s37, s93
	v_mfma_f32_4x4x4_16b_bf16 v[192:195], v[216:217], v[38:39], v[192:195]
	v_mfma_f32_4x4x4_16b_bf16 v[196:199], v[38:39], v[38:39], v[196:199]
	s_waitcnt lgkmcnt(9)
	v_mfma_f32_32x32x16_bf16 v[116:131], v[160:163], v[96:99], v[116:131]
	ds_read_b128 v[104:107], v203 offset:16384
	ds_read_b64_tr_b16 v[176:177], v221 offset:0
	ds_read_b64_tr_b16 v[178:179], v221 offset:512
	v_mfma_f32_4x4x4_16b_bf16 v[192:195], v[216:217], v[42:43], v[192:195]
	v_mfma_f32_4x4x4_16b_bf16 v[196:199], v[42:43], v[42:43], v[196:199]
	s_waitcnt vmcnt(7)
	s_barrier
	s_waitcnt lgkmcnt(9)
	v_mfma_f32_32x32x16_bf16 v[116:131], v[164:167], v[44:47], v[116:131]
	ds_read_b128 v[52:55], v200 offset:32768
	ds_read_b64_tr_b16 v[148:149], v218 offset:8192
	ds_read_b64_tr_b16 v[150:151], v218 offset:8704
	s_add_u32 m0, s30, 49152
	s_nop 0
	buffer_load_dwordx4 v1, s[12:15], s37 offen lds
	s_add_u32 s37, s37, s93
	v_mfma_f32_4x4x4_16b_bf16 v[180:183], v[216:217], v[164:165], v[180:183]
	v_mfma_f32_4x4x4_16b_bf16 v[192:195], v[216:217], v[44:45], v[192:195]
	v_mfma_f32_4x4x4_16b_bf16 v[196:199], v[44:45], v[44:45], v[196:199]
	s_waitcnt lgkmcnt(9)
	v_mfma_f32_32x32x16_bf16 v[116:131], v[168:171], v[48:51], v[116:131]
	ds_read_b128 v[56:59], v201 offset:32768
	ds_read_b64_tr_b16 v[152:153], v219 offset:8192
	ds_read_b64_tr_b16 v[154:155], v219 offset:8704
	v_mfma_f32_4x4x4_16b_bf16 v[180:183], v[216:217], v[166:167], v[180:183]
	v_mfma_f32_4x4x4_16b_bf16 v[192:195], v[216:217], v[48:49], v[192:195]
	v_mfma_f32_4x4x4_16b_bf16 v[196:199], v[48:49], v[48:49], v[196:199]
	s_waitcnt lgkmcnt(4)
	v_mfma_f32_4x4x4_16b_bf16 v[180:183], v[216:217], v[148:149], v[180:183]
	v_add_u32 v218, 0xfffe4000, v218
	v_mfma_f32_32x32x16_bf16 v[116:131], v[172:175], v[100:103], v[116:131]
	ds_read_b128 v[108:111], v202 offset:32768
	ds_read_b64_tr_b16 v[156:157], v220 offset:8192
	ds_read_b64_tr_b16 v[158:159], v220 offset:8704
	s_add_u32 m0, s30, 57344
	s_nop 0
	buffer_load_dwordx4 v1, s[12:15], s38 offen lds
	s_add_u32 s38, s38, s93
	v_mfma_f32_4x4x4_16b_bf16 v[192:195], v[216:217], v[46:47], v[192:195]
	v_mfma_f32_4x4x4_16b_bf16 v[196:199], v[46:47], v[46:47], v[196:199]
	s_waitcnt lgkmcnt(6)
	v_mfma_f32_4x4x4_16b_bf16 v[180:183], v[216:217], v[150:151], v[180:183]
	v_mfma_f32_4x4x4_16b_bf16 v[192:195], v[216:217], v[52:53], v[192:195]
	v_mfma_f32_4x4x4_16b_bf16 v[196:199], v[52:53], v[52:53], v[196:199]
	s_nop 0
	v_mfma_f32_4x4x4_16b_bf16 v[192:195], v[216:217], v[54:55], v[192:195]
	v_mfma_f32_4x4x4_16b_bf16 v[196:199], v[54:55], v[54:55], v[196:199]
	v_add_u32 v219, 0xfffe4000, v219
	v_mfma_f32_32x32x16_bf16 v[116:131], v[176:179], v[104:107], v[116:131]
	ds_read_b128 v[112:115], v203 offset:32768
	ds_read_b64_tr_b16 v[160:161], v221 offset:8192
	ds_read_b64_tr_b16 v[162:163], v221 offset:8704
	v_mfma_f32_4x4x4_16b_bf16 v[192:195], v[216:217], v[50:51], v[192:195]
	v_mfma_f32_4x4x4_16b_bf16 v[196:199], v[50:51], v[50:51], v[196:199]
	s_waitcnt lgkmcnt(8)
	v_mfma_f32_4x4x4_16b_bf16 v[192:195], v[216:217], v[56:57], v[192:195]
	v_mfma_f32_4x4x4_16b_bf16 v[196:199], v[56:57], v[56:57], v[196:199]
	s_nop 0
	v_mfma_f32_4x4x4_16b_bf16 v[192:195], v[216:217], v[58:59], v[192:195]
	v_mfma_f32_4x4x4_16b_bf16 v[196:199], v[58:59], v[58:59], v[196:199]
	v_add_u32 v220, 0xfffe4000, v220
	s_nop 3
	v_cndmask_b32 v196, v196, v197, s[42:43]
	v_cndmask_b32 v198, v198, v199, s[46:47]
	v_cndmask_b32 v193, v196, v198, s[44:45]
	ds_write_b64 v206, v[192:193]
	ds_write_b32 v223, v180 offset:0
	s_waitcnt vmcnt(5)
	s_waitcnt lgkmcnt(0)
	s_barrier
	v_mfma_f32_32x32x16_bf16 v[116:131], v[148:151], v[52:55], v[116:131]
	ds_read_b64_tr_b16 v[164:165], v218 offset:0
	ds_read_b64_tr_b16 v[166:167], v218 offset:512
	s_add_u32 m0, s30, 65536
	s_nop 0
	buffer_load_dwordx4 v1, s[12:15], s38 offen lds
	s_add_u32 s38, s38, s93
	v_add_u32 v221, 0xfffe4000, v221
	ds_read_b128 v[208:211], v207
	ds_read_b128 v[212:215], v207 offset:16
	s_waitcnt lgkmcnt(1)
	v_add_f32 v208, v208, v210
	s_waitcnt lgkmcnt(0)
	v_add_f32 v212, v212, v214
	v_add_f32 v209, v209, v211
	s_and_b32 s83, s2, 7
	s_lshr_b32 s84, s2, 3
	s_mul_i32 s85, s83, 24
	s_add_u32 s85, s85, 128
	v_mfma_f32_32x32x16_bf16 v[116:131], v[152:155], v[56:59], v[116:131]
	ds_read_b64_tr_b16 v[168:169], v219 offset:0
	ds_read_b64_tr_b16 v[170:171], v219 offset:512
	v_add_f32 v213, v213, v215
	v_add_f32 v208, v208, v212
	v_add_f32 v209, v209, v213
	v_mul_f32 v208, s51, v208
	v_mul_f32 v210, v208, v208
	v_fma_f32 v209, v209, s51, -v210
	v_max_f32 v209, 0, v209
	v_add_f32 v209, 0x3727c5ac, v209
	s_cmp_ge_u32 s84, 24
	s_cselect_b32 s6, 1, 0
	s_cselect_b32 s84, 0, s84
	s_cselect_b32 s70, 0, 1605632
	s_cselect_b32 s74, 0, 401408
	s_add_u32 s85, s85, s84
	s_mul_i32 s4, s85, 9363
	v_mfma_f32_32x32x16_bf16 v[116:131], v[156:159], v[108:111], v[116:131]
	ds_read_b64_tr_b16 v[172:173], v220 offset:0
	ds_read_b64_tr_b16 v[174:175], v220 offset:512
	s_add_u32 m0, s30, 73728
	s_nop 0
	buffer_load_dwordx4 v1, s[12:15], s38 offen lds
	s_add_u32 s38, s38, s93
	v_rsq_f32 v215, v209
	v_cvt_pk_bf16_f32 v210, v208, v208
	v_and_b32 v210, 0xffff0000, v210
	v_sub_f32 v210, v208, v210
	v_cvt_pk_bf16_f32 v188, v208, v210
	s_lshr_b32 s4, s4, 16
	s_mul_i32 s86, s4, 7
	s_sub_u32 s5, s85, s86
	s_lshl_b32 s5, s5, 7
	s_lshr_b32 s54, s24, 1
	v_mfma_f32_32x32x16_bf16 v[116:131], v[160:163], v[112:115], v[116:131]
	ds_read_b64_tr_b16 v[176:177], v221 offset:0
	ds_read_b64_tr_b16 v[178:179], v221 offset:512
	v_mul_f32 v209, v209, v215
	v_mul_f32 v222, 0x3fb8aa3b, v215
	v_cndmask_b32 v209, v209, 0, s[48:49]
	v_cvt_pk_bf16_f32 v211, v209, v209
	v_and_b32 v211, 0xffff0000, v211
	v_sub_f32 v211, v209, v211
	v_cvt_pk_bf16_f32 v189, v208, v209
	v_cvt_pk_bf16_f32 v190, v211, 0
	s_and_b32 s55, s24, 1
	s_lshl_b32 s83, s4, 1
	s_add_u32 s83, s83, s55
	s_lshl_b32 s7, s83, 12
	s_lshl_b32 s84, s54, 9
	s_add_u32 s7, s7, s84
	v_mfma_f32_32x32x16_bf16 v[132:147], v[4:7], v[164:167], 0
	ds_read_b64_tr_b16 v[148:149], v218 offset:8192
	ds_read_b64_tr_b16 v[150:151], v218 offset:8704
	s_add_u32 m0, s30, 81920
	s_nop 0
	buffer_load_dwordx4 v1, s[12:15], s38 offen lds
	s_add_u32 s38, s38, s93
	v_mfma_f32_4x4x4_16b_bf16 v[180:183], v[216:217], v[164:165], 0
	v_mov_b32 v191, 0
	ds_read_b128 v[208:211], v224 offset:0
	s_waitcnt lgkmcnt(0)
	v_add_f32 v208, v208, v209
	v_add_f32 v210, v210, v211
	s_mul_i32 s83, s83, 144
	s_add_u32 s83, s83, 2048
	s_mul_i32 s84, s54, 28
	s_add_u32 s88, s83, s84
	s_lshl_b32 s88, s88, 10
	v_mfma_f32_32x32x16_bf16 v[132:147], v[8:11], v[168:171], v[132:147]
	ds_read_b64_tr_b16 v[152:153], v219 offset:8192
	ds_read_b64_tr_b16 v[154:155], v219 offset:8704
	v_mfma_f32_4x4x4_16b_bf16 v[180:183], v[216:217], v[166:167], v[180:183]
	v_add_f32 v208, v208, v210
	v_cvt_pk_bf16_f32 v184, -v208, -v208
	v_and_b32 v210, 0xffff0000, v184
	v_add_f32 v210, v208, v210
	v_cvt_pk_bf16_f32 v185, -v210, 0
	v_mov_b32 v186, 0
	s_lshl_b32 s84, s54, 3
	s_add_u32 s89, s83, s84
	s_add_u32 s89, s89, 112
	s_lshl_b32 s89, s89, 10
	s_mul_i32 s83, s4, 57344
	s_add_u32 s94, s83, s5
	v_mfma_f32_32x32x16_bf16 v[132:147], v[60:63], v[172:175], v[132:147]
	ds_read_b64_tr_b16 v[156:157], v220 offset:8192
	ds_read_b64_tr_b16 v[158:159], v220 offset:8704
	s_add_u32 m0, s30, 90112
	s_nop 0
	buffer_load_dwordx4 v1, s[12:15], s38 offen lds
	s_add_u32 s38, s38, s93
	v_mfma_f32_32x32x16_bf16 v[116:131], v[184:187], v[188:191], v[116:131]
	ds_read_b64_tr_b16 v[200:201], v3 offset:0
	ds_read_b64_tr_b16 v[202:203], v3 offset:448
	ds_read_b64_tr_b16 v[204:205], v3 offset:896
	ds_read_b64_tr_b16 v[206:207], v3 offset:1344
	v_mfma_f32_32x32x16_bf16 v[132:147], v[64:67], v[176:179], v[132:147]
	ds_read_b64_tr_b16 v[160:161], v221 offset:8192
	ds_read_b64_tr_b16 v[162:163], v221 offset:8704
	v_mfma_f32_32x32x16_bf16 v[132:147], v[12:15], v[148:151], v[132:147]
	ds_read_b64_tr_b16 v[164:165], v218 offset:16384
	ds_read_b64_tr_b16 v[166:167], v218 offset:16896
	s_add_u32 m0, s30, 98304
	s_nop 0
	buffer_load_dwordx4 v1, s[12:15], s38 offen lds
	s_add_u32 s38, s38, s93
	v_mfma_f32_4x4x4_16b_bf16 v[180:183], v[216:217], v[148:149], v[180:183]
	v_cvt_pk_bf16_f32 v192, v116, v117
	v_cvt_pk_bf16_f32 v193, v118, v119
	v_cvt_pk_bf16_f32 v194, v120, v121
	s_waitcnt lgkmcnt(10)
	v_mfma_f32_32x32x16_bf16 v[132:147], v[16:19], v[152:155], v[132:147]
	ds_read_b64_tr_b16 v[168:169], v219 offset:16384
	ds_read_b64_tr_b16 v[170:171], v219 offset:16896
	v_mfma_f32_4x4x4_16b_bf16 v[180:183], v[216:217], v[150:151], v[180:183]
	v_cvt_pk_bf16_f32 v195, v122, v123
	v_cvt_pk_bf16_f32 v196, v124, v125
	v_cvt_pk_bf16_f32 v197, v126, v127
	v_cvt_pk_bf16_f32 v198, v128, v129
	v_cvt_pk_bf16_f32 v199, v130, v131
	s_waitcnt lgkmcnt(8)
	v_mfma_f32_32x32x16_bf16 v[116:131], v[200:203], v[192:195], 0
	v_mfma_f32_32x32x16_bf16 v[132:147], v[68:71], v[156:159], v[132:147]
	ds_read_b64_tr_b16 v[172:173], v220 offset:16384
	ds_read_b64_tr_b16 v[174:175], v220 offset:16896
	s_add_u32 m0, s30, 106496
	s_nop 0
	buffer_load_dwordx4 v1, s[12:15], s38 offen lds
	s_add_u32 s38, s38, s93
	s_waitcnt lgkmcnt(8)
	v_mfma_f32_32x32x16_bf16 v[116:131], v[204:207], v[196:199], v[116:131]
	s_waitcnt lgkmcnt(6)
	v_mfma_f32_32x32x16_bf16 v[132:147], v[72:75], v[160:163], v[132:147]
	ds_read_b64_tr_b16 v[176:177], v221 offset:16384
	ds_read_b64_tr_b16 v[178:179], v221 offset:16896
	s_waitcnt vmcnt(7)
	s_barrier
	s_waitcnt lgkmcnt(6)
	v_mfma_f32_32x32x16_bf16 v[132:147], v[20:23], v[164:167], v[132:147]
	ds_read_b64_tr_b16 v[148:149], v218 offset:24576
	ds_read_b64_tr_b16 v[150:151], v218 offset:25088
	v_mfma_f32_4x4x4_16b_bf16 v[180:183], v[216:217], v[164:165], v[180:183]
	s_nop 0
	v_max3_f32 v246, v116, v117, v118
	v_min3_f32 v247, v116, v117, v118
	v_max3_f32 v246, v246, v119, v120
	v_min3_f32 v247, v247, v119, v120
	v_max3_f32 v246, v246, v121, v122
	v_min3_f32 v247, v247, v121, v122
	v_max3_f32 v246, v246, v123, v124
	v_min3_f32 v247, v247, v123, v124
	v_max3_f32 v246, v246, v125, v126
	v_min3_f32 v247, v247, v125, v126
	v_max3_f32 v246, v246, v127, v128
	v_min3_f32 v247, v247, v127, v128
	v_max3_f32 v246, v246, v129, v130
	v_min3_f32 v247, v247, v129, v130
	s_waitcnt lgkmcnt(6)
	v_mfma_f32_32x32x16_bf16 v[132:147], v[24:27], v[168:171], v[132:147]
	ds_read_b64_tr_b16 v[152:153], v219 offset:24576
	ds_read_b64_tr_b16 v[154:155], v219 offset:25088
	v_mfma_f32_4x4x4_16b_bf16 v[180:183], v[216:217], v[166:167], v[180:183]
	v_max_f32 v246, v246, v131
	v_min_f32 v247, v247, v131
	v_xor_b32 v247, 0x80000000, v247
	s_nop 1
	v_permlane32_swap_b32 v246, v247
	v_max_f32 v246, v246, v247
	v_mul_f32 v246, v246, v222
	v_xor_b32 v246, 0x80000000, v246
	v_mov_b32 v247, v246
	s_nop 1
	v_permlane32_swap_b32 v246, v247
	v_mov_b32 v248, 0xf149f2ca
	v_cndmask_b32 v250, v246, v248, s[48:49]
	v_cndmask_b32 v251, v247, v248, s[48:49]
	v_fma_f32 v200, v116, v222, v246
	v_fma_f32 v201, v117, v222, v246
	s_waitcnt lgkmcnt(6)
	v_mfma_f32_32x32x16_bf16 v[132:147], v[76:79], v[172:175], v[132:147]
	ds_read_b64_tr_b16 v[156:157], v220 offset:24576
	ds_read_b64_tr_b16 v[158:159], v220 offset:25088
	v_fma_f32 v202, v118, v222, v246
	v_fma_f32 v203, v119, v222, v246
	v_fma_f32 v116, -v116, v222, v247
	v_fma_f32 v117, -v117, v222, v247
	v_fma_f32 v118, -v118, v222, v247
	v_fma_f32 v119, -v119, v222, v247
	v_exp_f32 v200, v200
	v_exp_f32 v201, v201
	v_exp_f32 v202, v202
	v_exp_f32 v203, v203
	v_exp_f32 v116, v116
	s_waitcnt lgkmcnt(6)
	v_mfma_f32_32x32x16_bf16 v[132:147], v[80:83], v[176:179], v[132:147]
	ds_read_b64_tr_b16 v[160:161], v221 offset:24576
	ds_read_b64_tr_b16 v[162:163], v221 offset:25088
	v_exp_f32 v117, v117
	v_exp_f32 v118, v118
	v_exp_f32 v119, v119
	v_fma_f32 v204, v120, v222, v246
	v_fma_f32 v205, v121, v222, v246
	v_fma_f32 v206, v122, v222, v246
	v_fma_f32 v207, v123, v222, v246
	v_fma_f32 v120, -v120, v222, v247
	v_fma_f32 v121, -v121, v222, v247
	v_fma_f32 v122, -v122, v222, v247
	v_fma_f32 v123, -v123, v222, v247
	v_exp_f32 v204, v204
	s_waitcnt lgkmcnt(6)
	v_mfma_f32_32x32x16_bf16 v[132:147], v[28:31], v[148:151], v[132:147]
	ds_read_b64_tr_b16 v[164:165], v218 offset:32768
	ds_read_b64_tr_b16 v[166:167], v218 offset:33280
	v_mfma_f32_4x4x4_16b_bf16 v[180:183], v[216:217], v[148:149], v[180:183]
	v_exp_f32 v205, v205
	v_exp_f32 v206, v206
	v_exp_f32 v207, v207
	v_exp_f32 v120, v120
	v_exp_f32 v121, v121
	v_exp_f32 v122, v122
	v_exp_f32 v123, v123
	v_fma_f32 v208, v124, v222, v246
	s_waitcnt lgkmcnt(6)
	v_mfma_f32_32x32x16_bf16 v[132:147], v[32:35], v[152:155], v[132:147]
	ds_read_b64_tr_b16 v[168:169], v219 offset:32768
	ds_read_b64_tr_b16 v[170:171], v219 offset:33280
	v_mfma_f32_4x4x4_16b_bf16 v[180:183], v[216:217], v[150:151], v[180:183]
	v_fma_f32 v209, v125, v222, v246
	v_fma_f32 v210, v126, v222, v246
	v_fma_f32 v211, v127, v222, v246
	v_fma_f32 v124, -v124, v222, v247
	v_fma_f32 v125, -v125, v222, v247
	v_fma_f32 v126, -v126, v222, v247
	v_fma_f32 v127, -v127, v222, v247
	v_exp_f32 v208, v208
	v_exp_f32 v209, v209
	v_exp_f32 v210, v210
	v_exp_f32 v211, v211
	s_waitcnt lgkmcnt(6)
	v_mfma_f32_32x32x16_bf16 v[132:147], v[84:87], v[156:159], v[132:147]
	ds_read_b64_tr_b16 v[172:173], v220 offset:32768
	ds_read_b64_tr_b16 v[174:175], v220 offset:33280
	v_exp_f32 v124, v124
	v_exp_f32 v125, v125
	v_exp_f32 v126, v126
	v_exp_f32 v127, v127
	v_fma_f32 v212, v128, v222, v250
	v_fma_f32 v213, v129, v222, v250
	v_fma_f32 v214, v130, v222, v250
	v_fma_f32 v215, v131, v222, v250
	v_fma_f32 v128, -v128, v222, v251
	v_fma_f32 v129, -v129, v222, v251
	v_fma_f32 v130, -v130, v222, v251
	v_fma_f32 v131, -v131, v222, v251
	s_waitcnt lgkmcnt(6)
	v_mfma_f32_32x32x16_bf16 v[132:147], v[88:91], v[160:163], v[132:147]
	ds_read_b64_tr_b16 v[176:177], v221 offset:32768
	ds_read_b64_tr_b16 v[178:179], v221 offset:33280
	v_exp_f32 v212, v212
	v_exp_f32 v213, v213
	v_exp_f32 v214, v214
	v_exp_f32 v215, v215
	v_exp_f32 v128, v128
	v_exp_f32 v129, v129
	v_exp_f32 v130, v130
	v_exp_f32 v131, v131
	s_waitcnt lgkmcnt(6)
	v_mfma_f32_32x32x16_bf16 v[132:147], v[36:39], v[164:167], v[132:147]
	ds_read_b64_tr_b16 v[148:149], v218 offset:40960
	ds_read_b64_tr_b16 v[150:151], v218 offset:41472
	v_mfma_f32_4x4x4_16b_bf16 v[180:183], v[216:217], v[164:165], v[180:183]
	s_nop 8
	v_readfirstlane_b32 s100, v229
	s_mov_b32 s53, 0
	s_nop 2
parallel_sum__linear_kernel_hedgehog__dense_activation_mish__prompt_kernel_tr3:
	s_cmp_lg_u32 s100, 0
	s_cbranch_scc1 parallel_sum__linear_kernel_hedgehog__dense_activation_mish__prompt_kernel_tk4
	v_mov_b32 v229, 0
	global_load_dword v229, v229, s[96:97] sc1
	s_waitcnt vmcnt(0)
	v_readfirstlane_b32 s100, v229
	s_add_u32 s53, s53, 1
	s_cmp_lt_u32 s53, 0x1000
	s_cbranch_scc1 parallel_sum__linear_kernel_hedgehog__dense_activation_mish__prompt_kernel_tr3
parallel_sum__linear_kernel_hedgehog__dense_activation_mish__prompt_kernel_tk4:
	s_and_b32 s100, s100, -8
	s_add_u32 s100, s100, 1
	s_nop 1
	v_add_f32 v248, v200, v201
	v_add_f32 v249, v116, v117
	v_add_f32 v248, v248, v202
	v_add_f32 v249, v249, v118
	v_add_f32 v248, v248, v203
	v_add_f32 v249, v249, v119
	v_add_f32 v248, v248, v204
	v_add_f32 v249, v249, v120
	v_add_f32 v248, v248, v205
	v_add_f32 v249, v249, v121
	v_add_f32 v248, v248, v206
	v_add_f32 v249, v249, v122
	v_add_f32 v248, v248, v207
	s_waitcnt lgkmcnt(6)
	v_mfma_f32_32x32x16_bf16 v[132:147], v[40:43], v[168:171], v[132:147]
	ds_read_b64_tr_b16 v[152:153], v219 offset:40960
	ds_read_b64_tr_b16 v[154:155], v219 offset:41472
	v_mfma_f32_4x4x4_16b_bf16 v[180:183], v[216:217], v[166:167], v[180:183]
	v_add_f32 v249, v249, v123
	v_add_f32 v248, v248, v208
	v_add_f32 v249, v249, v124
	v_add_f32 v248, v248, v209
	v_add_f32 v249, v249, v125
	v_add_f32 v248, v248, v210
	v_add_f32 v249, v249, v126
	v_add_f32 v248, v248, v211
	v_add_f32 v249, v249, v127
	v_add_f32 v248, v248, v212
	v_add_f32 v249, v249, v128
	v_add_f32 v248, v248, v213
	v_add_f32 v249, v249, v129
	v_add_f32 v248, v248, v214
	s_waitcnt lgkmcnt(6)
	v_mfma_f32_32x32x16_bf16 v[132:147], v[92:95], v[172:175], v[132:147]
	ds_read_b64_tr_b16 v[156:157], v220 offset:40960
	ds_read_b64_tr_b16 v[158:159], v220 offset:41472
	v_add_f32 v249, v249, v130
	v_add_f32 v248, v248, v215
	v_add_f32 v249, v249, v131
	s_nop 1
	v_permlane32_swap_b32 v248, v249
	v_add_f32 v248, v248, v249
	v_rcp_f32 v248, v248
	s_nop 0
	v_mul_f32 v248, v248, v222
	v_mov_b32 v249, v248
	s_nop 1
	v_permlane32_swap_b32 v248, v249
	v_mul_f32 v200, v200, v248
	v_mul_f32 v201, v201, v248
	v_cvt_pk_bf16_f32 v192, v200, v201
	v_mul_f32 v202, v202, v248
	v_mul_f32 v203, v203, v248
	v_cvt_pk_bf16_f32 v193, v202, v203
	s_waitcnt lgkmcnt(6)
	v_mfma_f32_32x32x16_bf16 v[132:147], v[96:99], v[176:179], v[132:147]
	ds_read_b64_tr_b16 v[160:161], v221 offset:40960
	ds_read_b64_tr_b16 v[162:163], v221 offset:41472
	v_mul_f32 v204, v204, v248
	v_mul_f32 v205, v205, v248
	v_cvt_pk_bf16_f32 v194, v204, v205
	v_mul_f32 v206, v206, v248
	v_mul_f32 v207, v207, v248
	v_cvt_pk_bf16_f32 v195, v206, v207
	v_mul_f32 v208, v208, v248
	v_mul_f32 v209, v209, v248
	v_cvt_pk_bf16_f32 v196, v208, v209
	v_mul_f32 v210, v210, v248
	v_mul_f32 v211, v211, v248
	v_cvt_pk_bf16_f32 v197, v210, v211
	v_mul_f32 v212, v212, v248
	v_mul_f32 v213, v213, v248
	v_cvt_pk_bf16_f32 v198, v212, v213
	v_mul_f32 v214, v214, v248
	v_mul_f32 v215, v215, v248
	s_waitcnt lgkmcnt(6)
	v_mfma_f32_32x32x16_bf16 v[132:147], v[44:47], v[148:151], v[132:147]
	ds_read_b64_tr_b16 v[164:165], v218 offset:49152
	ds_read_b64_tr_b16 v[166:167], v218 offset:49664
	v_mfma_f32_4x4x4_16b_bf16 v[180:183], v[216:217], v[148:149], v[180:183]
	v_cvt_pk_bf16_f32 v199, v214, v215
	v_mul_f32 v116, v116, v249
	v_mul_f32 v117, v117, v249
	v_cvt_pk_bf16_f32 v200, v116, v117
	v_mul_f32 v118, v118, v249
	v_mul_f32 v119, v119, v249
	v_cvt_pk_bf16_f32 v201, v118, v119
	v_mul_f32 v120, v120, v249
	v_mul_f32 v121, v121, v249
	v_cvt_pk_bf16_f32 v202, v120, v121
	v_mul_f32 v122, v122, v249
	v_mul_f32 v123, v123, v249
	v_cvt_pk_bf16_f32 v203, v122, v123
	v_mul_f32 v124, v124, v249
	s_waitcnt lgkmcnt(6)
	v_mfma_f32_32x32x16_bf16 v[132:147], v[48:51], v[152:155], v[132:147]
	ds_read_b64_tr_b16 v[168:169], v219 offset:49152
	ds_read_b64_tr_b16 v[170:171], v219 offset:49664
	v_mfma_f32_4x4x4_16b_bf16 v[180:183], v[216:217], v[150:151], v[180:183]
	s_waitcnt lgkmcnt(3)
	s_nop 0
	v_mfma_f32_4x4x4_16b_bf16 v[180:183], v[216:217], v[164:165], v[180:183]
	v_add_u32 v218, 0xe000, v218
	v_mul_f32 v125, v125, v249
	v_cvt_pk_bf16_f32 v204, v124, v125
	v_mul_f32 v126, v126, v249
	v_mul_f32 v127, v127, v249
	v_cvt_pk_bf16_f32 v205, v126, v127
	v_mul_f32 v128, v128, v249
	v_mul_f32 v129, v129, v249
	v_cvt_pk_bf16_f32 v206, v128, v129
	v_mul_f32 v130, v130, v249
	v_mul_f32 v131, v131, v249
	v_cvt_pk_bf16_f32 v207, v130, v131
	v_mfma_f32_32x32x16_bf16 v[132:147], v[100:103], v[156:159], v[132:147]
	ds_read_b64_tr_b16 v[172:173], v220 offset:49152
	ds_read_b64_tr_b16 v[174:175], v220 offset:49664
	s_waitcnt lgkmcnt(4)
	v_mfma_f32_4x4x4_16b_bf16 v[180:183], v[216:217], v[166:167], v[180:183]
	v_add_u32 v219, 0xe000, v219
	v_lshrrev_b32 v225, 3, v0
	v_and_b32 v226, 7, v0
	v_lshrrev_b32 v227, 2, v0
	v_and_b32 v227, 4, v227
	v_xor_b32 v226, v226, v227
	v_mfma_f32_32x32x16_bf16 v[116:131], v[192:195], v[236:239], 0
	v_mfma_f32_32x32x16_bf16 v[132:147], v[104:107], v[160:163], v[132:147]
	v_mfma_f32_32x32x16_bf16 v[116:131], v[196:199], v[240:243], v[116:131]
	ds_read_b64_tr_b16 v[176:177], v221 offset:49152
	ds_read_b64_tr_b16 v[178:179], v221 offset:49664
	v_add_u32 v220, 0xe000, v220
	ds_write_b32 v223, v180 offset:2048
	v_lshlrev_b32 v226, 4, v226
	s_lshl_b32 s83, s24, 3
	v_add_u32 v227, s83, v225
	s_movk_i32 s84, 896
	v_mad_u32_u24 v1, v227, s84, v226
	s_lshl_b32 s32, s26, 14
	s_add_u32 s32, s32, 114688
	s_lshl_b32 s33, s25, 12
	s_add_u32 s33, s33, s32
	v_add_u32 v246, s33, v2
	s_lshl_b32 s33, s25, 10
	s_add_u32 s33, s33, s32
	v_add_u32 v247, s33, v2
	s_waitcnt vmcnt(0)
	s_waitcnt lgkmcnt(0)
	s_barrier
	v_mfma_f32_32x32x16_bf16 v[132:147], v[52:55], v[164:167], v[132:147]
	ds_read_b64_tr_b16 v[148:149], v218 offset:0
	ds_read_b64_tr_b16 v[150:151], v218 offset:512
	v_add_u32 v221, 0xe000, v221
	v_cvt_pk_bf16_f32 v192, v116, v117
	v_cvt_pk_bf16_f32 v193, v118, v119
	v_cvt_pk_bf16_f32 v194, v120, v121
	v_cvt_pk_bf16_f32 v195, v122, v123
	v_cvt_pk_bf16_f32 v196, v124, v125
	v_cvt_pk_bf16_f32 v197, v126, v127
	v_cvt_pk_bf16_f32 v198, v128, v129
	v_cvt_pk_bf16_f32 v199, v130, v131
	v_mfma_f32_32x32x16_bf16 v[116:131], v[200:203], v[236:239], 0
	v_mfma_f32_32x32x16_bf16 v[132:147], v[56:59], v[168:171], v[132:147]
	v_mfma_f32_32x32x16_bf16 v[116:131], v[204:207], v[240:243], v[116:131]
	ds_read_b64_tr_b16 v[152:153], v219 offset:0
	ds_read_b64_tr_b16 v[154:155], v219 offset:512
	s_add_u32 m0, s30, 0
	s_nop 0
	buffer_load_dwordx4 v1, s[68:71], s5 offen lds
	ds_read_b128 v[180:183], v224 offset:2048
	s_waitcnt lgkmcnt(0)
	v_add_f32 v180, v180, v181
	v_add_f32 v182, v182, v183
	v_add_f32 v180, v180, v182
	v_cvt_pk_bf16_f32 v184, -v180, -v180
	v_mfma_f32_32x32x16_bf16 v[132:147], v[108:111], v[172:175], v[132:147]
	ds_read_b64_tr_b16 v[156:157], v220 offset:0
	ds_read_b64_tr_b16 v[158:159], v220 offset:512
	s_add_u32 m0, s30, 8192
	s_add_u32 s81, s5, 401408
	buffer_load_dwordx4 v1, s[68:71], s81 offen lds
	v_and_b32 v182, 0xffff0000, v184
	v_add_f32 v182, v180, v182
	v_cvt_pk_bf16_f32 v185, -v182, v252
	v_mov_b32 v186, v253
	v_mfma_f32_32x32x16_bf16 v[132:147], v[112:115], v[176:179], v[132:147]
	ds_read_b64_tr_b16 v[160:161], v221 offset:0
	ds_read_b64_tr_b16 v[162:163], v221 offset:512
	s_add_u32 m0, s30, 16384
	s_add_u32 s81, s5, 802816
	buffer_load_dwordx4 v1, s[68:71], s81 offen lds
	v_cvt_pk_bf16_f32 v208, v116, v117
	v_cvt_pk_bf16_f32 v209, v118, v119
	v_cvt_pk_bf16_f32 v210, v120, v121
	v_cvt_pk_bf16_f32 v211, v122, v123
	v_cvt_pk_bf16_f32 v212, v124, v125
	v_cvt_pk_bf16_f32 v213, v126, v127
	v_cvt_pk_bf16_f32 v214, v128, v129
	v_cvt_pk_bf16_f32 v215, v130, v131
	v_mfma_f32_32x32x16_bf16 v[132:147], v[188:191], v[184:187], v[132:147]
	v_mfma_f32_32x32x16_bf16 v[116:131], v[148:151], v[4:7], 0
	ds_read_b64_tr_b16 v[164:165], v218 offset:8192
	ds_read_b64_tr_b16 v[166:167], v218 offset:8704
	s_add_u32 m0, s30, 24576
	s_add_u32 s81, s5, 1204224
	buffer_load_dwordx4 v1, s[68:71], s81 offen lds
	v_mfma_f32_4x4x4_16b_bf16 v[180:183], v[216:217], v[148:149], 0
	s_nop 4
	v_cvt_pk_bf16_f32 v200, v132, v133
	v_cvt_pk_bf16_f32 v201, v134, v135
	v_cvt_pk_bf16_f32 v202, v136, v137
	v_cvt_pk_bf16_f32 v203, v138, v139
	v_cvt_pk_bf16_f32 v204, v140, v141
	v_cvt_pk_bf16_f32 v205, v142, v143
	v_cvt_pk_bf16_f32 v206, v144, v145
	v_cvt_pk_bf16_f32 v207, v146, v147
	v_mfma_f32_32x32x16_bf16 v[132:147], v[192:195], v[200:203], 0
	s_nop 0
	v_mfma_f32_32x32x16_bf16 v[132:147], v[196:199], v[204:207], v[132:147]
	v_mfma_f32_32x32x16_bf16 v[116:131], v[152:155], v[8:11], v[116:131]
	ds_read_b64_tr_b16 v[168:169], v219 offset:8192
	ds_read_b64_tr_b16 v[170:171], v219 offset:8704
	v_mfma_f32_4x4x4_16b_bf16 v[180:183], v[216:217], v[150:151], v[180:183]
	s_nop 7
	v_cvt_pk_bf16_f32 v192, v132, v133
	v_cvt_pk_bf16_f32 v193, v134, v135
	v_cvt_pk_bf16_f32 v194, v136, v137
	v_cvt_pk_bf16_f32 v195, v138, v139
	v_cvt_pk_bf16_f32 v196, v140, v141
	v_cvt_pk_bf16_f32 v197, v142, v143
	v_cvt_pk_bf16_f32 v198, v144, v145
	v_cvt_pk_bf16_f32 v199, v146, v147
	v_mfma_f32_32x32x16_bf16 v[132:147], v[208:211], v[200:203], 0
	v_mfma_f32_32x32x16_bf16 v[132:147], v[212:215], v[204:207], v[132:147]
	ds_write_b128 v246, v[192:195] offset:0
	ds_write_b128 v246, v[196:199] offset:1024
	s_waitcnt lgkmcnt(8)
	v_mfma_f32_32x32x16_bf16 v[116:131], v[156:159], v[60:63], v[116:131]
	ds_read_b64_tr_b16 v[172:173], v220 offset:8192
	ds_read_b64_tr_b16 v[174:175], v220 offset:8704
	s_nop 5
	v_cvt_pk_bf16_f32 v200, v132, v133
	v_cvt_pk_bf16_f32 v201, v134, v135
	v_cvt_pk_bf16_f32 v202, v136, v137
	v_cvt_pk_bf16_f32 v203, v138, v139
	v_cvt_pk_bf16_f32 v204, v140, v141
	v_cvt_pk_bf16_f32 v205, v142, v143
	v_cvt_pk_bf16_f32 v206, v144, v145
	v_cvt_pk_bf16_f32 v207, v146, v147
	ds_write_b128 v246, v[200:203] offset:2048
	ds_write_b128 v246, v[204:207] offset:3072
	s_waitcnt lgkmcnt(10)
	v_mfma_f32_32x32x16_bf16 v[116:131], v[160:163], v[64:67], v[116:131]
	ds_read_b64_tr_b16 v[176:177], v221 offset:8192
	ds_read_b64_tr_b16 v[178:179], v221 offset:8704
	s_waitcnt lgkmcnt(2)
	s_barrier
	v_mfma_f32_32x32x16_bf16 v[116:131], v[164:167], v[12:15], v[116:131]
	ds_read_b64_tr_b16 v[148:149], v218 offset:16384
	ds_read_b64_tr_b16 v[150:151], v218 offset:16896
	v_mfma_f32_4x4x4_16b_bf16 v[180:183], v[216:217], v[164:165], v[180:183]
	ds_read_b128 v[200:203], v247 offset:0
	ds_read_b128 v[204:207], v247 offset:4096
	ds_read_b128 v[208:211], v247 offset:8192
	ds_read_b128 v[212:215], v247 offset:12288
	v_mfma_f32_32x32x16_bf16 v[116:131], v[168:171], v[16:19], v[116:131]
	ds_read_b64_tr_b16 v[152:153], v219 offset:16384
	ds_read_b64_tr_b16 v[154:155], v219 offset:16896
	v_mfma_f32_4x4x4_16b_bf16 v[180:183], v[216:217], v[166:167], v[180:183]
	s_waitcnt lgkmcnt(5)
	v_mfma_f32_4x4x4_16b_bf16 v[132:135], v[244:245], v[200:201], 0
	v_mfma_f32_4x4x4_16b_bf16 v[136:139], v[244:245], v[202:203], 0
	s_waitcnt lgkmcnt(4)
	v_mfma_f32_4x4x4_16b_bf16 v[132:135], v[244:245], v[204:205], v[132:135]
	v_mfma_f32_4x4x4_16b_bf16 v[136:139], v[244:245], v[206:207], v[136:139]
	v_mfma_f32_32x32x16_bf16 v[116:131], v[172:175], v[68:71], v[116:131]
	ds_read_b64_tr_b16 v[156:157], v220 offset:16384
	ds_read_b64_tr_b16 v[158:159], v220 offset:16896
	s_waitcnt lgkmcnt(5)
	v_mfma_f32_4x4x4_16b_bf16 v[132:135], v[244:245], v[208:209], v[132:135]
	v_mfma_f32_4x4x4_16b_bf16 v[136:139], v[244:245], v[210:211], v[136:139]
	s_waitcnt lgkmcnt(4)
	v_mfma_f32_4x4x4_16b_bf16 v[132:135], v[244:245], v[212:213], v[132:135]
	v_mfma_f32_4x4x4_16b_bf16 v[136:139], v[244:245], v[214:215], v[136:139]
	v_mfma_f32_32x32x16_bf16 v[116:131], v[176:179], v[72:75], v[116:131]
	ds_read_b64_tr_b16 v[160:161], v221 offset:16384
	ds_read_b64_tr_b16 v[162:163], v221 offset:16896
	s_nop 0
	v_cvt_pk_bf16_f32 v140, v132, v133
	v_cvt_pk_bf16_f32 v141, v134, v135
	v_cvt_pk_bf16_f32 v142, v136, v137
	v_cvt_pk_bf16_f32 v143, v138, v139
	buffer_store_dwordx4 v[140:143], v2, s[16:19], s57 offen sc1
	v_mfma_f32_32x32x16_bf16 v[116:131], v[148:151], v[20:23], v[116:131]
	ds_read_b64_tr_b16 v[164:165], v218 offset:24576
	ds_read_b64_tr_b16 v[166:167], v218 offset:25088
	s_add_u32 m0, s30, 32768
	s_add_u32 s81, s5, 229376
	buffer_load_dwordx4 v1, s[68:71], s81 offen lds
	v_mfma_f32_4x4x4_16b_bf16 v[180:183], v[216:217], v[148:149], v[180:183]
	s_waitcnt lgkmcnt(6)
	v_mfma_f32_32x32x16_bf16 v[116:131], v[152:155], v[24:27], v[116:131]
	ds_read_b64_tr_b16 v[168:169], v219 offset:24576
	ds_read_b64_tr_b16 v[170:171], v219 offset:25088
	s_add_u32 m0, s30, 40960
	s_add_u32 s81, s5, 630784
	buffer_load_dwordx4 v1, s[68:71], s81 offen lds
	v_mfma_f32_4x4x4_16b_bf16 v[180:183], v[216:217], v[150:151], v[180:183]
	s_waitcnt lgkmcnt(6)
	v_mfma_f32_32x32x16_bf16 v[116:131], v[156:159], v[76:79], v[116:131]
	ds_read_b64_tr_b16 v[172:173], v220 offset:24576
	ds_read_b64_tr_b16 v[174:175], v220 offset:25088
	s_add_u32 m0, s30, 49152
	s_add_u32 s81, s5, 1032192
	buffer_load_dwordx4 v1, s[68:71], s81 offen lds
	s_mov_b64 exec, 0xf
	buffer_load_dword v230, v231, s[16:19], s7 offen offset:2048 sc1
	s_mov_b64 exec, -1
	s_waitcnt lgkmcnt(6)
	v_mfma_f32_32x32x16_bf16 v[116:131], v[160:163], v[80:83], v[116:131]
	ds_read_b64_tr_b16 v[176:177], v221 offset:24576
	ds_read_b64_tr_b16 v[178:179], v221 offset:25088
	s_add_u32 m0, s30, 57344
	s_add_u32 s81, s5, 1433600
	buffer_load_dwordx4 v1, s[68:71], s81 offen lds
	s_waitcnt vmcnt(5)
	s_barrier
	s_waitcnt lgkmcnt(6)
	v_mfma_f32_32x32x16_bf16 v[116:131], v[164:167], v[28:31], v[116:131]
	ds_read_b64_tr_b16 v[148:149], v218 offset:32768
	ds_read_b64_tr_b16 v[150:151], v218 offset:33280
	v_add_u32 v227, s95, v232
	s_add_u32 s53, s100, 0
	v_mov_b32 v228, s53
	s_mov_b32 exec_hi, 0
	buffer_store_dword v228, v227, s[16:19], s58 offen sc1
	s_mov_b64 exec, -1
	v_mfma_f32_4x4x4_16b_bf16 v[180:183], v[216:217], v[164:165], v[180:183]
	s_waitcnt lgkmcnt(6)
	v_mfma_f32_32x32x16_bf16 v[116:131], v[168:171], v[32:35], v[116:131]
	ds_read_b64_tr_b16 v[152:153], v219 offset:32768
	ds_read_b64_tr_b16 v[154:155], v219 offset:33280
	s_add_u32 m0, s30, 114688
	s_add_u32 s81, s5, 57344
	buffer_load_dwordx4 v1, s[68:71], s81 offen lds
	v_mfma_f32_4x4x4_16b_bf16 v[180:183], v[216:217], v[166:167], v[180:183]
	s_waitcnt lgkmcnt(6)
	v_mfma_f32_32x32x16_bf16 v[116:131], v[172:175], v[84:87], v[116:131]
	ds_read_b64_tr_b16 v[156:157], v220 offset:32768
	ds_read_b64_tr_b16 v[158:159], v220 offset:33280
	s_add_u32 m0, s30, 122880
	s_add_u32 s81, s5, 458752
	buffer_load_dwordx4 v1, s[68:71], s81 offen lds
	s_waitcnt lgkmcnt(6)
	v_mfma_f32_32x32x16_bf16 v[116:131], v[176:179], v[88:91], v[116:131]
	ds_read_b64_tr_b16 v[160:161], v221 offset:32768
	ds_read_b64_tr_b16 v[162:163], v221 offset:33280
	s_add_u32 m0, s30, 131072
	s_add_u32 s81, s5, 860160
	buffer_load_dwordx4 v1, s[68:71], s81 offen lds
	s_waitcnt lgkmcnt(6)
	v_mfma_f32_32x32x16_bf16 v[116:131], v[148:151], v[36:39], v[116:131]
	ds_read_b64_tr_b16 v[164:165], v218 offset:40960
	ds_read_b64_tr_b16 v[166:167], v218 offset:41472
	s_add_u32 m0, s30, 139264
	s_add_u32 s81, s5, 1261568
	buffer_load_dwordx4 v1, s[68:71], s81 offen lds
	v_mfma_f32_4x4x4_16b_bf16 v[180:183], v[216:217], v[148:149], v[180:183]
	s_waitcnt lgkmcnt(6)
	v_mfma_f32_32x32x16_bf16 v[116:131], v[152:155], v[40:43], v[116:131]
	ds_read_b64_tr_b16 v[168:169], v219 offset:40960
	ds_read_b64_tr_b16 v[170:171], v219 offset:41472
	s_waitcnt vmcnt(6)
	s_nop 8
	s_mov_b32 s53, 0
	s_add_u32 s35, s100, 0
parallel_sum__linear_kernel_hedgehog__dense_activation_mish__prompt_kernel_pl5:
	v_subrev_u32 v228, s35, v230
	v_cmp_gt_u32 vcc, 7, v228
	s_nop 3
	s_and_b32 s34, vcc_lo, 15
	s_cmp_eq_u32 s34, 15
	s_cbranch_scc1 parallel_sum__linear_kernel_hedgehog__dense_activation_mish__prompt_kernel_pk6
	s_mov_b64 exec, 0xf
	buffer_load_dword v230, v231, s[16:19], s7 offen offset:2048 sc1
	s_mov_b64 exec, -1
	s_add_u32 s53, s53, 1
	s_waitcnt vmcnt(0)
	s_cmp_lt_u32 s53, 0x1000
	s_cbranch_scc1 parallel_sum__linear_kernel_hedgehog__dense_activation_mish__prompt_kernel_pl5
parallel_sum__linear_kernel_hedgehog__dense_activation_mish__prompt_kernel_pk6:
	s_nop 1
	buffer_load_dwordx4 v[4:7], v2, s[16:19], s88 offen offset:0
	v_mfma_f32_4x4x4_16b_bf16 v[180:183], v[216:217], v[150:151], v[180:183]
	s_waitcnt lgkmcnt(6)
	v_mfma_f32_32x32x16_bf16 v[116:131], v[156:159], v[92:95], v[116:131]
	ds_read_b64_tr_b16 v[172:173], v220 offset:40960
	ds_read_b64_tr_b16 v[174:175], v220 offset:41472
	buffer_load_dwordx4 v[8:11], v2, s[16:19], s88 offen offset:1024
	s_waitcnt lgkmcnt(6)
	v_mfma_f32_32x32x16_bf16 v[116:131], v[160:163], v[96:99], v[116:131]
	ds_read_b64_tr_b16 v[176:177], v221 offset:40960
	ds_read_b64_tr_b16 v[178:179], v221 offset:41472
	buffer_load_dwordx4 v[12:15], v2, s[16:19], s88 offen offset:2048
	s_barrier
	s_waitcnt lgkmcnt(6)
	v_mfma_f32_32x32x16_bf16 v[116:131], v[164:167], v[44:47], v[116:131]
	ds_read_b64_tr_b16 v[148:149], v218 offset:49152
	ds_read_b64_tr_b16 v[150:151], v218 offset:49664
	s_add_u32 m0, s30, 65536
	s_add_u32 s81, s5, 286720
	buffer_load_dwordx4 v1, s[68:71], s81 offen lds
	buffer_load_dwordx4 v[16:19], v2, s[16:19], s88 offen offset:3072
	v_mfma_f32_4x4x4_16b_bf16 v[180:183], v[216:217], v[164:165], v[180:183]
	s_waitcnt lgkmcnt(6)
	v_mfma_f32_32x32x16_bf16 v[116:131], v[168:171], v[48:51], v[116:131]
	ds_read_b64_tr_b16 v[152:153], v219 offset:49152
	ds_read_b64_tr_b16 v[154:155], v219 offset:49664
	s_add_u32 m0, s30, 73728
	s_add_u32 s81, s5, 688128
	buffer_load_dwordx4 v1, s[68:71], s81 offen lds
	v_mfma_f32_4x4x4_16b_bf16 v[180:183], v[216:217], v[166:167], v[180:183]
	s_waitcnt lgkmcnt(3)
	s_nop 0
	v_mfma_f32_4x4x4_16b_bf16 v[180:183], v[216:217], v[148:149], v[180:183]
	v_mfma_f32_32x32x16_bf16 v[116:131], v[172:175], v[100:103], v[116:131]
	ds_read_b64_tr_b16 v[156:157], v220 offset:49152
	ds_read_b64_tr_b16 v[158:159], v220 offset:49664
	s_add_u32 m0, s30, 81920
	s_add_u32 s81, s5, 1089536
	buffer_load_dwordx4 v1, s[68:71], s81 offen lds
	s_waitcnt lgkmcnt(4)
	v_mfma_f32_4x4x4_16b_bf16 v[180:183], v[216:217], v[150:151], v[180:183]
	v_mfma_f32_32x32x16_bf16 v[116:131], v[176:179], v[104:107], v[116:131]
	ds_read_b64_tr_b16 v[160:161], v221 offset:49152
	ds_read_b64_tr_b16 v[162:163], v221 offset:49664
	s_add_u32 m0, s30, 90112
	s_add_u32 s81, s5, 1490944
	buffer_load_dwordx4 v1, s[68:71], s81 offen lds
	v_add_u32 v227, s95, v231
	s_mov_b64 exec, 0xffff
	buffer_load_dword v229, v227, s[16:19], s59 offen offset:0 sc1
	s_mov_b64 exec, -1
	ds_write_b32 v223, v180 offset:0
	v_mfma_f32_32x32x16_bf16 v[116:131], v[148:151], v[52:55], v[116:131]
	s_add_u32 s80, s88, 16384
	buffer_load_dwordx4 v[60:63], v2, s[16:19], s80 offen offset:0
	s_waitcnt lgkmcnt(5)
	v_mfma_f32_32x32x16_bf16 v[116:131], v[152:155], v[56:59], v[116:131]
	buffer_load_dwordx4 v[64:67], v2, s[16:19], s80 offen offset:1024
	s_waitcnt lgkmcnt(3)
	v_mfma_f32_32x32x16_bf16 v[116:131], v[156:159], v[108:111], v[116:131]
	buffer_load_dwordx4 v[68:71], v2, s[16:19], s80 offen offset:2048
	s_waitcnt lgkmcnt(1)
	v_mfma_f32_32x32x16_bf16 v[116:131], v[160:163], v[112:115], v[116:131]
	buffer_load_dwordx4 v[72:75], v2, s[16:19], s80 offen offset:3072
	s_mov_b64 exec, 0xf
	buffer_load_dword v230, v231, s[16:19], s7 offen offset:2048 sc1
	s_mov_b64 exec, -1
	s_waitcnt vmcnt(5)
	s_nop 6
	s_mov_b32 s53, 0
	s_cmp_lg_u32 s24, 0
	s_cbranch_scc1 parallel_sum__linear_kernel_hedgehog__dense_activation_mish__prompt_kernel_pk8
	s_add_u32 s35, s100, 0
parallel_sum__linear_kernel_hedgehog__dense_activation_mish__prompt_kernel_pl7:
	v_subrev_u32 v228, s35, v229
	v_cmp_gt_u32 vcc, 7, v228
	s_nop 3
	s_and_b32 s34, vcc_lo, s52
	s_cmp_eq_u32 s34, s52
	s_cbranch_scc1 parallel_sum__linear_kernel_hedgehog__dense_activation_mish__prompt_kernel_pk8
	s_mov_b64 exec, 0xffff
	buffer_load_dword v229, v231, s[16:19], s59 offen offset:0 sc1
	s_mov_b64 exec, -1
	s_add_u32 s53, s53, 1
	s_waitcnt vmcnt(0)
	s_cmp_lt_u32 s53, 0x1000
	s_cbranch_scc1 parallel_sum__linear_kernel_hedgehog__dense_activation_mish__prompt_kernel_pl7
parallel_sum__linear_kernel_hedgehog__dense_activation_mish__prompt_kernel_pk8:
	s_nop 1
	s_waitcnt lgkmcnt(0)
	s_barrier
	buffer_load_dwordx4 v[148:151], v2, s[16:19], s56 offen
	s_add_u32 s56, s56, 8192
	buffer_load_dwordx4 v[152:155], v2, s[16:19], s56 offen
	s_add_u32 s56, s56, 8192
	buffer_load_dwordx4 v[156:159], v2, s[16:19], s56 offen
	s_add_u32 s56, s56, 8192
	ds_read_b128 v[180:183], v224 offset:0
	s_waitcnt lgkmcnt(0)
	v_add_f32 v180, v180, v181
	v_add_f32 v182, v182, v183
	v_add_f32 v180, v180, v182
	v_cvt_pk_bf16_f32 v184, -v180, -v180
	v_and_b32 v182, 0xffff0000, v184
	v_add_f32 v182, v180, v182
	v_cvt_pk_bf16_f32 v185, -v182, 0
	v_mov_b32 v186, 0
	buffer_load_dwordx4 v[160:163], v2, s[16:19], s56 offen
	s_add_u32 s56, s56, 8192
	v_mfma_f32_32x32x16_bf16 v[116:131], v[184:187], v[188:191], v[116:131]
	ds_read_b64_tr_b16 v[200:201], v3 offset:0
	ds_read_b64_tr_b16 v[202:203], v3 offset:448
	ds_read_b64_tr_b16 v[204:205], v3 offset:896
	ds_read_b64_tr_b16 v[206:207], v3 offset:1344
	s_nop 7
	v_cvt_pk_bf16_f32 v192, v116, v117
	v_cvt_pk_bf16_f32 v193, v118, v119
	v_cvt_pk_bf16_f32 v194, v120, v121
	v_cvt_pk_bf16_f32 v195, v122, v123
	buffer_load_dwordx4 v[164:167], v2, s[16:19], s56 offen
	s_add_u32 s56, s56, 8192
	v_cvt_pk_bf16_f32 v196, v124, v125
	v_cvt_pk_bf16_f32 v197, v126, v127
	v_cvt_pk_bf16_f32 v198, v128, v129
	v_cvt_pk_bf16_f32 v199, v130, v131
	s_waitcnt lgkmcnt(2)
	v_mfma_f32_32x32x16_bf16 v[116:131], v[200:203], v[192:195], 0
	s_waitcnt lgkmcnt(0)
	v_mfma_f32_32x32x16_bf16 v[116:131], v[204:207], v[196:199], v[116:131]
	s_nop 11
	v_max3_f32 v246, v116, v117, v118
	v_min3_f32 v247, v116, v117, v118
	v_max3_f32 v246, v246, v119, v120
	buffer_load_dwordx4 v[168:171], v2, s[16:19], s56 offen
	s_add_u32 s56, s56, 8192
	v_min3_f32 v247, v247, v119, v120
	v_max3_f32 v246, v246, v121, v122
	v_min3_f32 v247, v247, v121, v122
	v_max3_f32 v246, v246, v123, v124
	v_min3_f32 v247, v247, v123, v124
	v_max3_f32 v246, v246, v125, v126
	v_min3_f32 v247, v247, v125, v126
	v_max3_f32 v246, v246, v127, v128
	v_min3_f32 v247, v247, v127, v128
	buffer_load_dwordx4 v[172:175], v2, s[16:19], s56 offen
	s_add_u32 s56, s56, 8192
	v_max3_f32 v246, v246, v129, v130
	v_min3_f32 v247, v247, v129, v130
	v_max_f32 v246, v246, v131
	v_min_f32 v247, v247, v131
	v_xor_b32 v247, 0x80000000, v247
	s_nop 1
	v_permlane32_swap_b32 v246, v247
	v_max_f32 v246, v246, v247
	v_mul_f32 v246, v246, v222
	v_xor_b32 v246, 0x80000000, v246
	buffer_load_dwordx4 v[176:179], v2, s[16:19], s56 offen
	s_add_u32 s56, s56, 8192
	v_mov_b32 v247, v246
	s_nop 1
	v_permlane32_swap_b32 v246, v247
	v_mov_b32 v248, 0xf149f2ca
	v_cndmask_b32 v250, v246, v248, s[48:49]
	v_cndmask_b32 v251, v247, v248, s[48:49]
	v_fma_f32 v200, v116, v222, v246
	v_fma_f32 v201, v117, v222, v246
	v_fma_f32 v202, v118, v222, v246
	v_fma_f32 v203, v119, v222, v246
	buffer_load_dwordx4 v[36:39], v2, s[16:19], s56 offen
	s_add_u32 s56, s56, 8192
	v_fma_f32 v116, -v116, v222, v247
	v_fma_f32 v117, -v117, v222, v247
	v_fma_f32 v118, -v118, v222, v247
	v_fma_f32 v119, -v119, v222, v247
	v_exp_f32 v200, v200
	v_exp_f32 v201, v201
	v_exp_f32 v202, v202
	v_exp_f32 v203, v203
	v_exp_f32 v116, v116
	buffer_load_dwordx4 v[40:43], v2, s[16:19], s56 offen
	s_add_u32 s56, s56, 8192
	v_exp_f32 v117, v117
	v_exp_f32 v118, v118
	v_exp_f32 v119, v119
	v_fma_f32 v204, v120, v222, v246
	v_fma_f32 v205, v121, v222, v246
	v_fma_f32 v206, v122, v222, v246
	v_fma_f32 v207, v123, v222, v246
	v_fma_f32 v120, -v120, v222, v247
	v_fma_f32 v121, -v121, v222, v247
	buffer_load_dwordx4 v[44:47], v2, s[16:19], s56 offen
	s_add_u32 s56, s56, 8192
	v_fma_f32 v122, -v122, v222, v247
	v_fma_f32 v123, -v123, v222, v247
	v_exp_f32 v204, v204
	v_exp_f32 v205, v205
	v_exp_f32 v206, v206
	v_exp_f32 v207, v207
	v_exp_f32 v120, v120
	v_exp_f32 v121, v121
	v_exp_f32 v122, v122
	buffer_load_dwordx4 v[48:51], v2, s[16:19], s56 offen
	s_add_u32 s56, s56, 8192
	v_exp_f32 v123, v123
	v_fma_f32 v208, v124, v222, v246
	v_fma_f32 v209, v125, v222, v246
	v_fma_f32 v210, v126, v222, v246
	v_fma_f32 v211, v127, v222, v246
	v_fma_f32 v124, -v124, v222, v247
	v_fma_f32 v125, -v125, v222, v247
	v_fma_f32 v126, -v126, v222, v247
	v_fma_f32 v127, -v127, v222, v247
	buffer_load_dwordx4 v[52:55], v2, s[16:19], s56 offen
	s_add_u32 s56, s56, 8192
	v_exp_f32 v208, v208
	v_exp_f32 v209, v209
	v_exp_f32 v210, v210
	v_exp_f32 v211, v211
	v_exp_f32 v124, v124
	v_exp_f32 v125, v125
	v_exp_f32 v126, v126
	v_exp_f32 v127, v127
	v_fma_f32 v212, v128, v222, v250
	buffer_load_dwordx4 v[56:59], v2, s[16:19], s56 offen
	s_add_u32 s56, s56, 8192
	v_fma_f32 v213, v129, v222, v250
	v_fma_f32 v214, v130, v222, v250
	v_fma_f32 v215, v131, v222, v250
	v_fma_f32 v128, -v128, v222, v251
	v_fma_f32 v129, -v129, v222, v251
	v_fma_f32 v130, -v130, v222, v251
	v_fma_f32 v131, -v131, v222, v251
	v_exp_f32 v212, v212
	v_exp_f32 v213, v213
	buffer_load_dwordx4 v[108:111], v2, s[16:19], s56 offen
	s_add_u32 s56, s56, 8192
	v_exp_f32 v214, v214
	v_exp_f32 v215, v215
	v_exp_f32 v128, v128
	v_exp_f32 v129, v129
	v_exp_f32 v130, v130
	v_exp_f32 v131, v131
	v_cvt_pk_bf16_f32 v192, v200, v201
	v_cvt_pk_bf16_f32 v193, v202, v203
	v_cvt_pk_bf16_f32 v194, v204, v205
	buffer_load_dwordx4 v[112:115], v2, s[16:19], s56 offen
	v_cvt_pk_bf16_f32 v195, v206, v207
	v_cvt_pk_bf16_f32 v196, v208, v209
	v_cvt_pk_bf16_f32 v197, v210, v211
	v_cvt_pk_bf16_f32 v198, v212, v213
	v_cvt_pk_bf16_f32 v199, v214, v215
	v_cvt_pk_bf16_f32 v200, v116, v117
	v_cvt_pk_bf16_f32 v201, v118, v119
	v_cvt_pk_bf16_f32 v202, v120, v121
	v_cvt_pk_bf16_f32 v203, v122, v123
	v_cvt_pk_bf16_f32 v204, v124, v125
	v_cvt_pk_bf16_f32 v205, v126, v127
	v_cvt_pk_bf16_f32 v206, v128, v129
	v_cvt_pk_bf16_f32 v207, v130, v131
	v_lshrrev_b32 v218, 5, v0
	v_lshlrev_b32 v218, 9, v218
	v_bfe_u32 v219, v0, 2, 2
	v_lshl_add_u32 v218, v219, 7, v218
	v_bfe_u32 v219, v0, 4, 1
	v_lshl_add_u32 v218, v219, 5, v218
	v_and_b32 v219, 3, v0
	v_lshl_add_u32 v218, v219, 3, v218
	v_bfe_u32 v219, v0, 3, 1
	v_lshl_add_u32 v218, v219, 6, v218
	s_lshl_b32 s83, s54, 13
	v_add_u32 v218, s83, v218
	v_xor_b32 v219, 64, v218
	s_waitcnt vmcnt(16)
	s_nop 0
	s_mov_b32 s53, 0
	s_add_u32 s35, s100, 1
parallel_sum__linear_kernel_hedgehog__dense_activation_mish__prompt_kernel_pl9:
	v_subrev_u32 v228, s35, v230
	v_cmp_gt_u32 vcc, 6, v228
	s_nop 3
	s_and_b32 s34, vcc_lo, 15
	s_cmp_eq_u32 s34, 15
	s_cbranch_scc1 parallel_sum__linear_kernel_hedgehog__dense_activation_mish__prompt_kernel_pk10
	s_mov_b64 exec, 0xf
	buffer_load_dword v230, v231, s[16:19], s7 offen offset:2048 sc1
	s_mov_b64 exec, -1
	s_add_u32 s53, s53, 1
	s_waitcnt vmcnt(0)
	s_cmp_lt_u32 s53, 0x1000
	s_cbranch_scc1 parallel_sum__linear_kernel_hedgehog__dense_activation_mish__prompt_kernel_pl9
parallel_sum__linear_kernel_hedgehog__dense_activation_mish__prompt_kernel_pk10:
	s_nop 1
	s_waitcnt vmcnt(15)
	v_mfma_f32_4x4x4_16b_bf16 v[132:135], v[244:245], v[148:149], 0
	v_mfma_f32_4x4x4_16b_bf16 v[136:139], v[244:245], v[150:151], 0
	s_waitcnt vmcnt(14)
	v_mfma_f32_4x4x4_16b_bf16 v[132:135], v[244:245], v[152:153], v[132:135]
	v_mfma_f32_4x4x4_16b_bf16 v[136:139], v[244:245], v[154:155], v[136:139]
	s_add_u32 s82, s88, 4096
	buffer_load_dwordx4 v[20:23], v2, s[16:19], s82 offen offset:0
	s_waitcnt vmcnt(14)
	v_mfma_f32_4x4x4_16b_bf16 v[132:135], v[244:245], v[156:157], v[132:135]
	v_mfma_f32_4x4x4_16b_bf16 v[136:139], v[244:245], v[158:159], v[136:139]
	s_waitcnt vmcnt(13)
	v_mfma_f32_4x4x4_16b_bf16 v[132:135], v[244:245], v[160:161], v[132:135]
	v_mfma_f32_4x4x4_16b_bf16 v[136:139], v[244:245], v[162:163], v[136:139]
	buffer_load_dwordx4 v[24:27], v2, s[16:19], s82 offen offset:1024
	s_waitcnt vmcnt(13)
	v_mfma_f32_4x4x4_16b_bf16 v[132:135], v[244:245], v[164:165], v[132:135]
	v_mfma_f32_4x4x4_16b_bf16 v[136:139], v[244:245], v[166:167], v[136:139]
	s_waitcnt vmcnt(12)
	v_mfma_f32_4x4x4_16b_bf16 v[132:135], v[244:245], v[168:169], v[132:135]
	v_mfma_f32_4x4x4_16b_bf16 v[136:139], v[244:245], v[170:171], v[136:139]
	buffer_load_dwordx4 v[28:31], v2, s[16:19], s82 offen offset:2048
	s_waitcnt vmcnt(12)
	v_mfma_f32_4x4x4_16b_bf16 v[132:135], v[244:245], v[172:173], v[132:135]
	v_mfma_f32_4x4x4_16b_bf16 v[136:139], v[244:245], v[174:175], v[136:139]
	s_waitcnt vmcnt(11)
	v_mfma_f32_4x4x4_16b_bf16 v[132:135], v[244:245], v[176:177], v[132:135]
	v_mfma_f32_4x4x4_16b_bf16 v[136:139], v[244:245], v[178:179], v[136:139]
	buffer_load_dwordx4 v[32:35], v2, s[16:19], s82 offen offset:3072
	s_waitcnt vmcnt(11)
	v_mfma_f32_4x4x4_16b_bf16 v[132:135], v[244:245], v[36:37], v[132:135]
	v_mfma_f32_4x4x4_16b_bf16 v[136:139], v[244:245], v[38:39], v[136:139]
	s_waitcnt vmcnt(10)
	v_mfma_f32_4x4x4_16b_bf16 v[132:135], v[244:245], v[40:41], v[132:135]
	v_mfma_f32_4x4x4_16b_bf16 v[136:139], v[244:245], v[42:43], v[136:139]
	s_add_u32 s80, s88, 20480
	buffer_load_dwordx4 v[76:79], v2, s[16:19], s80 offen offset:0
	s_waitcnt vmcnt(10)
	v_mfma_f32_4x4x4_16b_bf16 v[132:135], v[244:245], v[44:45], v[132:135]
	v_mfma_f32_4x4x4_16b_bf16 v[136:139], v[244:245], v[46:47], v[136:139]
	s_waitcnt vmcnt(9)
	v_mfma_f32_4x4x4_16b_bf16 v[132:135], v[244:245], v[48:49], v[132:135]
	v_mfma_f32_4x4x4_16b_bf16 v[136:139], v[244:245], v[50:51], v[136:139]
	buffer_load_dwordx4 v[80:83], v2, s[16:19], s80 offen offset:1024
	s_waitcnt vmcnt(9)
	v_mfma_f32_4x4x4_16b_bf16 v[132:135], v[244:245], v[52:53], v[132:135]
	v_mfma_f32_4x4x4_16b_bf16 v[136:139], v[244:245], v[54:55], v[136:139]
	s_waitcnt vmcnt(8)
	v_mfma_f32_4x4x4_16b_bf16 v[132:135], v[244:245], v[56:57], v[132:135]
	v_mfma_f32_4x4x4_16b_bf16 v[136:139], v[244:245], v[58:59], v[136:139]
	buffer_load_dwordx4 v[84:87], v2, s[16:19], s80 offen offset:2048
	s_waitcnt vmcnt(8)
	v_mfma_f32_4x4x4_16b_bf16 v[132:135], v[244:245], v[108:109], v[132:135]
	v_mfma_f32_4x4x4_16b_bf16 v[136:139], v[244:245], v[110:111], v[136:139]
	s_waitcnt vmcnt(7)
	v_mfma_f32_4x4x4_16b_bf16 v[132:135], v[244:245], v[112:113], v[132:135]
	v_mfma_f32_4x4x4_16b_bf16 v[136:139], v[244:245], v[114:115], v[136:139]
	buffer_load_dwordx4 v[88:91], v2, s[16:19], s80 offen offset:3072
	s_nop 2
	v_cvt_pk_bf16_f32 v140, v132, v133
	v_cvt_pk_bf16_f32 v141, v134, v135
	v_cvt_pk_bf16_f32 v142, v136, v137
	v_cvt_pk_bf16_f32 v143, v138, v139
	v_cndmask_b32 v140, v140, v216, s[60:61]
	v_cndmask_b32 v141, v141, v216, s[60:61]
	v_cndmask_b32 v142, v142, v216, s[60:61]
	v_cndmask_b32 v143, v143, v216, s[60:61]
	s_lshl_b32 s32, s25, 10
	s_lshl_b32 s33, s26, 13
	s_add_u32 s33, s33, 151552
	v_add_u32 v247, s33, v2
	v_add_u32 v246, s32, v247
	ds_write_b128 v246, v[140:143]
	s_waitcnt lgkmcnt(0)
	s_barrier
	ds_read_b128 v[148:151], v247 offset:0
	ds_read_b128 v[152:155], v247 offset:1024
	ds_read_b128 v[156:159], v247 offset:2048
	ds_read_b128 v[160:163], v247 offset:3072
	s_waitcnt lgkmcnt(3)
	v_mfma_f32_32x32x16_bf16 v[116:131], v[148:151], v[192:195], 0
	s_waitcnt lgkmcnt(1)
	v_mfma_f32_32x32x16_bf16 v[132:147], v[156:159], v[200:203], 0
	v_mfma_f32_32x32x16_bf16 v[116:131], v[152:155], v[196:199], v[116:131]
	s_waitcnt lgkmcnt(0)
	v_mfma_f32_32x32x16_bf16 v[132:147], v[160:163], v[204:207], v[132:147]
	s_nop 9
	v_rcp_f32 v246, v130
	s_nop 0
	v_rcp_f32 v247, v146
	v_add_f32 v248, v128, v129
	v_add_f32 v249, v144, v145
	v_mov_b32 v250, 0x35c1a2a0
	v_fmac_f32 v250, v248, v246
	v_fmac_f32 v250, v249, v247
	v_rcp_f32 v250, v250
	s_nop 0
	v_mul_f32 v250, 0x3fb8aa3b, v250
	v_mul_f32 v246, v246, v250
	v_mul_f32 v247, v247, v250
	v_mov_b32 v248, v246
	v_mov_b32 v249, v247
	s_nop 0
	v_permlane32_swap_b32 v248, v246
	v_permlane32_swap_b32 v249, v247
	v_cndmask_b32 v250, v246, 0, s[48:49]
	v_cndmask_b32 v251, v247, 0, s[48:49]
	v_mul_f32 v116, v116, v246
	v_fmac_f32 v116, v132, v247
	v_mul_f32 v117, v117, v246
	v_fmac_f32 v117, v133, v247
	v_mul_f32 v118, v118, v246
	v_fmac_f32 v118, v134, v247
	v_mul_f32 v119, v119, v246
	v_fmac_f32 v119, v135, v247
	v_mul_f32 v120, v120, v246
	v_fmac_f32 v120, v136, v247
	v_mul_f32 v121, v121, v246
	v_fmac_f32 v121, v137, v247
	v_mul_f32 v122, v122, v246
	v_fmac_f32 v122, v138, v247
	v_mul_f32 v123, v123, v246
	v_fmac_f32 v123, v139, v247
	v_mul_f32 v124, v124, v246
	v_fmac_f32 v124, v140, v247
	v_mul_f32 v125, v125, v246
	v_fmac_f32 v125, v141, v247
	v_mul_f32 v126, v126, v246
	v_fmac_f32 v126, v142, v247
	v_mul_f32 v127, v127, v246
	v_fmac_f32 v127, v143, v247
	v_mul_f32 v128, v128, v250
	v_fmac_f32 v128, v144, v251
	v_mul_f32 v129, v129, v250
	v_fmac_f32 v129, v145, v251
	v_mul_f32 v130, v130, v250
	v_fmac_f32 v130, v146, v251
	v_mul_f32 v131, v131, v250
	v_fmac_f32 v131, v147, v251
	v_cvt_pk_bf16_f32 v192, v116, v117
	v_cvt_pk_bf16_f32 v193, v118, v119
	v_cvt_pk_bf16_f32 v194, v120, v121
	v_cvt_pk_bf16_f32 v195, v122, v123
	buffer_store_dwordx4 v[192:195], v2, s[16:19], s40 offen offset:0 sc1
	v_cvt_pk_bf16_f32 v196, v124, v125
	v_cvt_pk_bf16_f32 v197, v126, v127
	v_cvt_pk_bf16_f32 v198, v128, v129
	v_cvt_pk_bf16_f32 v199, v130, v131
	buffer_store_dwordx4 v[196:199], v2, s[16:19], s40 offen offset:1024 sc1
	s_cmp_lg_u32 s6, 0
	s_nop 0
	s_cbranch_scc1 parallel_sum__linear_kernel_hedgehog__dense_activation_mish__prompt_kernel_idle
	s_barrier
	ds_read_b64_tr_b16 v[148:149], v218 offset:0
	ds_read_b64_tr_b16 v[150:151], v218 offset:1024
	s_add_u32 m0, s30, 98304
	s_add_u32 s81, s5, 114688
	buffer_load_dwordx4 v1, s[68:71], s81 offen lds
	s_mov_b64 exec, 0xf
	buffer_load_dword v230, v231, s[16:19], s7 offen offset:2048 sc1
	s_mov_b64 exec, -1
	v_lshrrev_b32 v225, 3, v0
	v_and_b32 v226, 7, v0
	s_lshl_b32 s83, s24, 3
	ds_read_b64_tr_b16 v[152:153], v219 offset:0
	ds_read_b64_tr_b16 v[154:155], v219 offset:1024
	s_add_u32 m0, s30, 106496
	s_add_u32 s81, s5, 516096
	buffer_load_dwordx4 v1, s[68:71], s81 offen lds
	v_add_u32 v227, s83, v225
	s_movk_i32 s84, 896
	ds_read_b64_tr_b16 v[156:157], v218 offset:2048
	ds_read_b64_tr_b16 v[158:159], v218 offset:3072
	s_add_u32 m0, s30, 147456
	s_add_u32 s81, s5, 917504
	buffer_load_dwordx4 v1, s[68:71], s81 offen lds
	v_lshlrev_b32 v220, 4, v226
	v_mad_u32_u24 v220, v227, s84, v220
	buffer_load_dwordx4 v[184:187], v220, s[8:11], s94 offen
	ds_read_b64_tr_b16 v[160:161], v219 offset:2048
	ds_read_b64_tr_b16 v[162:163], v219 offset:3072
	s_add_u32 m0, s30, 155648
	s_add_u32 s81, s5, 1318912
	buffer_load_dwordx4 v1, s[68:71], s81 offen lds
	v_mul_u32_u24 v224, 272, v227
	v_lshl_add_u32 v224, v226, 5, v224
	s_and_b32 s83, s24, 3
	s_waitcnt lgkmcnt(6)
	v_mfma_f32_32x32x16_bf16 v[116:131], v[148:151], v[4:7], 0
	ds_read_b64_tr_b16 v[164:165], v218 offset:4096
	ds_read_b64_tr_b16 v[166:167], v218 offset:5120
	s_lshl_b32 s83, s83, 3
	v_add_u32 v225, s83, v225
	v_min_u32 v225, 27, v225
	s_lshr_b32 s83, s24, 2
	s_mul_i32 s83, s83, 28
	s_waitcnt lgkmcnt(6)
	v_mfma_f32_32x32x16_bf16 v[132:147], v[152:155], v[4:7], 0
	ds_read_b64_tr_b16 v[168:169], v219 offset:4096
	ds_read_b64_tr_b16 v[170:171], v219 offset:5120
	v_add_u32 v225, s83, v225
	v_lshrrev_b32 v227, 2, v0
	v_and_b32 v227, 4, v227
	v_xor_b32 v226, v226, v227
	v_lshlrev_b32 v226, 4, v226
	v_mad_u32_u24 v3, v225, s84, v226
	s_waitcnt lgkmcnt(6)
	v_mfma_f32_32x32x16_bf16 v[116:131], v[156:159], v[8:11], v[116:131]
	ds_read_b64_tr_b16 v[172:173], v218 offset:6144
	ds_read_b64_tr_b16 v[174:175], v218 offset:7168
	v_and_b32 v225, 31, v0
	s_lshl_b32 s83, s55, 5
	v_add_u32 v225, s83, v225
	v_mul_u32_u24 v225, 272, v225
	s_mul_i32 s83, s54, 17408
	s_waitcnt lgkmcnt(6)
	v_mfma_f32_32x32x16_bf16 v[132:147], v[160:163], v[8:11], v[132:147]
	ds_read_b64_tr_b16 v[176:177], v219 offset:6144
	ds_read_b64_tr_b16 v[178:179], v219 offset:7168
	s_lshr_b32 s84, s54, 1
	s_mul_i32 s84, s84, 63488
	s_add_u32 s83, s83, s84
	v_add_u32 v225, s83, v225
	v_lshrrev_b32 v226, 5, v0
	v_lshl_add_u32 v223, v226, 4, v225
	s_barrier
	s_waitcnt lgkmcnt(6)
	v_mfma_f32_32x32x16_bf16 v[116:131], v[164:167], v[12:15], v[116:131]
	ds_read_b64_tr_b16 v[148:149], v218 offset:32768
	ds_read_b64_tr_b16 v[150:151], v218 offset:33792
	s_waitcnt vmcnt(6)
	s_add_u32 s53, s100, 4
	v_mov_b32 v228, s53
	s_mov_b32 exec_hi, 0
	buffer_store_dword v228, v232, s[16:19], s101 offen sc1
	s_mov_b64 exec, -1
	s_waitcnt lgkmcnt(6)
	v_mfma_f32_32x32x16_bf16 v[132:147], v[168:171], v[12:15], v[132:147]
	ds_read_b64_tr_b16 v[152:153], v219 offset:32768
	ds_read_b64_tr_b16 v[154:155], v219 offset:33792
	s_waitcnt vmcnt(5)
	s_nop 8
	s_mov_b32 s53, 0
	s_add_u32 s35, s100, 2
parallel_sum__linear_kernel_hedgehog__dense_activation_mish__prompt_kernel_pl11:
	v_subrev_u32 v228, s35, v230
	v_cmp_gt_u32 vcc, 5, v228
	s_nop 3
	s_and_b32 s34, vcc_lo, 15
	s_cmp_eq_u32 s34, 15
	s_cbranch_scc1 parallel_sum__linear_kernel_hedgehog__dense_activation_mish__prompt_kernel_pk12
	s_mov_b64 exec, 0xf
	buffer_load_dword v230, v231, s[16:19], s7 offen offset:2048 sc1
	s_mov_b64 exec, -1
	s_add_u32 s53, s53, 1
	s_waitcnt vmcnt(0)
	s_cmp_lt_u32 s53, 0x1000
	s_cbranch_scc1 parallel_sum__linear_kernel_hedgehog__dense_activation_mish__prompt_kernel_pl11
parallel_sum__linear_kernel_hedgehog__dense_activation_mish__prompt_kernel_pk12:
	s_nop 1
	s_add_u32 s82, s88, 8192
	buffer_load_dwordx4 v[92:95], v2, s[16:19], s82 offen offset:0
	s_waitcnt lgkmcnt(6)
	v_mfma_f32_32x32x16_bf16 v[116:131], v[172:175], v[16:19], v[116:131]
	ds_read_b64_tr_b16 v[156:157], v218 offset:34816
	ds_read_b64_tr_b16 v[158:159], v218 offset:35840
	buffer_load_dwordx4 v[96:99], v2, s[16:19], s82 offen offset:1024
	s_waitcnt lgkmcnt(6)
	v_mfma_f32_32x32x16_bf16 v[132:147], v[176:179], v[16:19], v[132:147]
	ds_read_b64_tr_b16 v[160:161], v219 offset:34816
	ds_read_b64_tr_b16 v[162:163], v219 offset:35840
	buffer_load_dwordx4 v[100:103], v2, s[16:19], s82 offen offset:2048
	s_mov_b64 exec, 0xf
	buffer_load_dword v230, v231, s[16:19], s7 offen offset:2048 sc1
	s_mov_b64 exec, -1
	s_waitcnt lgkmcnt(6)
	v_mfma_f32_32x32x16_bf16 v[116:131], v[148:151], v[60:63], v[116:131]
	ds_read_b64_tr_b16 v[164:165], v218 offset:36864
	ds_read_b64_tr_b16 v[166:167], v218 offset:37888
	buffer_load_dwordx4 v[104:107], v2, s[16:19], s82 offen offset:3072
	s_waitcnt lgkmcnt(6)
	v_mfma_f32_32x32x16_bf16 v[132:147], v[152:155], v[60:63], v[132:147]
	ds_read_b64_tr_b16 v[168:169], v219 offset:36864
	ds_read_b64_tr_b16 v[170:171], v219 offset:37888
	s_add_u32 s80, s88, 24576
	buffer_load_dwordx4 v[36:39], v2, s[16:19], s80 offen offset:0
	s_waitcnt lgkmcnt(6)
	v_mfma_f32_32x32x16_bf16 v[116:131], v[156:159], v[64:67], v[116:131]
	ds_read_b64_tr_b16 v[172:173], v218 offset:38912
	ds_read_b64_tr_b16 v[174:175], v218 offset:39936
	buffer_load_dwordx4 v[40:43], v2, s[16:19], s80 offen offset:1024
	s_waitcnt lgkmcnt(6)
	v_mfma_f32_32x32x16_bf16 v[132:147], v[160:163], v[64:67], v[132:147]
	ds_read_b64_tr_b16 v[176:177], v219 offset:38912
	ds_read_b64_tr_b16 v[178:179], v219 offset:39936
	buffer_load_dwordx4 v[44:47], v2, s[16:19], s80 offen offset:2048
	s_barrier
	s_waitcnt lgkmcnt(6)
	v_mfma_f32_32x32x16_bf16 v[116:131], v[164:167], v[68:71], v[116:131]
	v_add_u32 v218, 0x1c000, v218
	v_add_u32 v219, 0x1c000, v219
	ds_read_b64_tr_b16 v[148:149], v218 offset:0
	ds_read_b64_tr_b16 v[150:151], v218 offset:1024
	buffer_load_dwordx4 v[48:51], v2, s[16:19], s80 offen offset:3072
	s_add_u32 m0, s30, 0
	s_add_u32 s81, s5, 344064
	buffer_load_dwordx4 v1, s[68:71], s81 offen lds
	s_waitcnt lgkmcnt(6)
	v_mfma_f32_32x32x16_bf16 v[132:147], v[168:171], v[68:71], v[132:147]
	ds_read_b64_tr_b16 v[152:153], v219 offset:0
	ds_read_b64_tr_b16 v[154:155], v219 offset:1024
	s_add_u32 m0, s30, 8192
	s_add_u32 s81, s5, 745472
	buffer_load_dwordx4 v1, s[68:71], s81 offen lds
	s_waitcnt lgkmcnt(6)
	v_mfma_f32_32x32x16_bf16 v[116:131], v[172:175], v[72:75], v[116:131]
	ds_read_b64_tr_b16 v[156:157], v218 offset:2048
	ds_read_b64_tr_b16 v[158:159], v218 offset:3072
	s_add_u32 m0, s30, 16384
	s_add_u32 s81, s5, 1146880
	buffer_load_dwordx4 v1, s[68:71], s81 offen lds
	s_waitcnt lgkmcnt(6)
	v_mfma_f32_32x32x16_bf16 v[132:147], v[176:179], v[72:75], v[132:147]
	ds_read_b64_tr_b16 v[160:161], v219 offset:2048
	ds_read_b64_tr_b16 v[162:163], v219 offset:3072
	s_add_u32 m0, s30, 24576
	s_add_u32 s81, s5, 1548288
	buffer_load_dwordx4 v1, s[68:71], s81 offen lds
	s_waitcnt lgkmcnt(6)
	v_mfma_f32_32x32x16_bf16 v[116:131], v[148:151], v[20:23], v[116:131]
	ds_read_b64_tr_b16 v[164:165], v218 offset:4096
	ds_read_b64_tr_b16 v[166:167], v218 offset:5120
	s_waitcnt vmcnt(9)
	s_nop 8
	s_mov_b32 s53, 0
	s_add_u32 s35, s100, 3
parallel_sum__linear_kernel_hedgehog__dense_activation_mish__prompt_kernel_pl13:
	v_subrev_u32 v228, s35, v230
	v_cmp_gt_u32 vcc, 4, v228
	s_nop 3
	s_and_b32 s34, vcc_lo, 15
	s_cmp_eq_u32 s34, 15
	s_cbranch_scc1 parallel_sum__linear_kernel_hedgehog__dense_activation_mish__prompt_kernel_pk14
	s_mov_b64 exec, 0xf
	buffer_load_dword v230, v231, s[16:19], s7 offen offset:2048 sc1
	s_mov_b64 exec, -1
	s_add_u32 s53, s53, 1
	s_waitcnt vmcnt(0)
	s_cmp_lt_u32 s53, 0x1000
	s_cbranch_scc1 parallel_sum__linear_kernel_hedgehog__dense_activation_mish__prompt_kernel_pl13
parallel_sum__linear_kernel_hedgehog__dense_activation_mish__prompt_kernel_pk14:
	s_nop 1
	s_add_u32 s82, s88, 12288
	buffer_load_dwordx4 v[52:55], v2, s[16:19], s82 offen offset:0
	s_waitcnt lgkmcnt(6)
	v_mfma_f32_32x32x16_bf16 v[132:147], v[152:155], v[20:23], v[132:147]
	ds_read_b64_tr_b16 v[168:169], v219 offset:4096
	ds_read_b64_tr_b16 v[170:171], v219 offset:5120
	buffer_load_dwordx4 v[56:59], v2, s[16:19], s82 offen offset:1024
	s_waitcnt lgkmcnt(6)
	v_mfma_f32_32x32x16_bf16 v[116:131], v[156:159], v[24:27], v[116:131]
	ds_read_b64_tr_b16 v[172:173], v218 offset:6144
	ds_read_b64_tr_b16 v[174:175], v218 offset:7168
	buffer_load_dwordx4 v[108:111], v2, s[16:19], s82 offen offset:2048
	s_waitcnt lgkmcnt(6)
	v_mfma_f32_32x32x16_bf16 v[132:147], v[160:163], v[24:27], v[132:147]
	ds_read_b64_tr_b16 v[176:177], v219 offset:6144
	ds_read_b64_tr_b16 v[178:179], v219 offset:7168
	buffer_load_dwordx4 v[112:115], v2, s[16:19], s82 offen offset:3072
	s_barrier
	s_waitcnt lgkmcnt(6)
	v_mfma_f32_32x32x16_bf16 v[116:131], v[164:167], v[28:31], v[116:131]
	v_add_u32 v218, 0xffff4000, v218
	v_add_u32 v219, 0xffff4000, v219
	ds_read_b64_tr_b16 v[148:149], v218 offset:0
	ds_read_b64_tr_b16 v[150:151], v218 offset:1024
	s_add_u32 m0, s30, 32768
	s_add_u32 s81, s5, 172032
	buffer_load_dwordx4 v1, s[68:71], s81 offen lds
	s_waitcnt lgkmcnt(6)
	v_mfma_f32_32x32x16_bf16 v[132:147], v[168:171], v[28:31], v[132:147]
	ds_read_b64_tr_b16 v[152:153], v219 offset:0
	ds_read_b64_tr_b16 v[154:155], v219 offset:1024
	s_add_u32 m0, s30, 40960
	s_add_u32 s81, s5, 573440
	buffer_load_dwordx4 v1, s[68:71], s81 offen lds
	s_waitcnt lgkmcnt(6)
	v_mfma_f32_32x32x16_bf16 v[116:131], v[172:175], v[32:35], v[116:131]
	ds_read_b64_tr_b16 v[156:157], v218 offset:2048
	ds_read_b64_tr_b16 v[158:159], v218 offset:3072
	s_add_u32 m0, s30, 49152
	s_add_u32 s81, s5, 974848
	buffer_load_dwordx4 v1, s[68:71], s81 offen lds
	s_waitcnt lgkmcnt(6)
	v_mfma_f32_32x32x16_bf16 v[132:147], v[176:179], v[32:35], v[132:147]
	ds_read_b64_tr_b16 v[160:161], v219 offset:2048
	ds_read_b64_tr_b16 v[162:163], v219 offset:3072
	s_add_u32 m0, s30, 57344
	s_add_u32 s81, s5, 1376256
	buffer_load_dwordx4 v1, s[68:71], s81 offen lds
	s_waitcnt lgkmcnt(6)
	v_mfma_f32_32x32x16_bf16 v[116:131], v[148:151], v[76:79], v[116:131]
	ds_read_b64_tr_b16 v[164:165], v218 offset:4096
	ds_read_b64_tr_b16 v[166:167], v218 offset:5120
	s_mov_b64 exec, 0xf
	buffer_load_dword v230, v231, s[16:19], s7 offen offset:0 sc1
	s_mov_b64 exec, -1
	s_waitcnt lgkmcnt(6)
	v_mfma_f32_32x32x16_bf16 v[132:147], v[152:155], v[76:79], v[132:147]
	ds_read_b64_tr_b16 v[168:169], v219 offset:4096
	ds_read_b64_tr_b16 v[170:171], v219 offset:5120
	s_waitcnt lgkmcnt(6)
	v_mfma_f32_32x32x16_bf16 v[116:131], v[156:159], v[80:83], v[116:131]
	ds_read_b64_tr_b16 v[172:173], v218 offset:6144
	ds_read_b64_tr_b16 v[174:175], v218 offset:7168
	s_waitcnt lgkmcnt(6)
	v_mfma_f32_32x32x16_bf16 v[132:147], v[160:163], v[80:83], v[132:147]
	ds_read_b64_tr_b16 v[176:177], v219 offset:6144
	ds_read_b64_tr_b16 v[178:179], v219 offset:7168
	s_barrier
	s_waitcnt lgkmcnt(6)
	v_mfma_f32_32x32x16_bf16 v[116:131], v[164:167], v[84:87], v[116:131]
	s_lshr_b32 s32, s54, 1
	s_mul_i32 s32, s32, 0x8000
	s_add_u32 s32, s32, 0x8000
	v_add_u32 v218, s32, v218
	v_add_u32 v219, s32, v219
	ds_read_b64_tr_b16 v[148:149], v218 offset:0
	ds_read_b64_tr_b16 v[150:151], v218 offset:1024
	s_add_u32 m0, s30, 114688
	s_nop 0
	buffer_load_dwordx4 v3, s[72:75], s5 offen lds
	s_waitcnt lgkmcnt(6)
	v_mfma_f32_32x32x16_bf16 v[132:147], v[168:171], v[84:87], v[132:147]
	ds_read_b64_tr_b16 v[152:153], v219 offset:0
	ds_read_b64_tr_b16 v[154:155], v219 offset:1024
	s_add_u32 m0, s30, 122880
	s_add_u32 s81, s5, 100352
	buffer_load_dwordx4 v3, s[72:75], s81 offen lds
	s_waitcnt lgkmcnt(6)
	v_mfma_f32_32x32x16_bf16 v[116:131], v[172:175], v[88:91], v[116:131]
	ds_read_b64_tr_b16 v[156:157], v218 offset:2048
	ds_read_b64_tr_b16 v[158:159], v218 offset:3072
	s_add_u32 m0, s30, 131072
	s_add_u32 s81, s5, 200704
	buffer_load_dwordx4 v3, s[72:75], s81 offen lds
	s_waitcnt lgkmcnt(6)
	v_mfma_f32_32x32x16_bf16 v[132:147], v[176:179], v[88:91], v[132:147]
	ds_read_b64_tr_b16 v[160:161], v219 offset:2048
	ds_read_b64_tr_b16 v[162:163], v219 offset:3072
	s_add_u32 m0, s30, 139264
	s_add_u32 s81, s5, 301056
	buffer_load_dwordx4 v3, s[72:75], s81 offen lds
	s_waitcnt lgkmcnt(6)
	v_mfma_f32_32x32x16_bf16 v[116:131], v[148:151], v[92:95], v[116:131]
	ds_read_b64_tr_b16 v[164:165], v218 offset:4096
	ds_read_b64_tr_b16 v[166:167], v218 offset:5120
	s_waitcnt vmcnt(4)
	s_nop 8
	s_mov_b32 s53, 0
	s_add_u32 s35, s100, 4
parallel_sum__linear_kernel_hedgehog__dense_activation_mish__prompt_kernel_pl15:
	v_subrev_u32 v228, s35, v230
	v_cmp_gt_u32 vcc, 3, v228
	s_nop 3
	s_and_b32 s34, vcc_lo, 15
	s_cmp_eq_u32 s34, 15
	s_cbranch_scc1 parallel_sum__linear_kernel_hedgehog__dense_activation_mish__prompt_kernel_pk16
	s_mov_b64 exec, 0xf
	buffer_load_dword v230, v231, s[16:19], s7 offen offset:0 sc1
	s_mov_b64 exec, -1
	s_add_u32 s53, s53, 1
	s_waitcnt vmcnt(0)
	s_cmp_lt_u32 s53, 0x1000
	s_cbranch_scc1 parallel_sum__linear_kernel_hedgehog__dense_activation_mish__prompt_kernel_pl15
parallel_sum__linear_kernel_hedgehog__dense_activation_mish__prompt_kernel_pk16:
	s_nop 1
	buffer_load_dwordx4 v[4:7], v2, s[16:19], s89 offen offset:0
	s_waitcnt lgkmcnt(6)
	v_mfma_f32_32x32x16_bf16 v[132:147], v[152:155], v[92:95], v[132:147]
	ds_read_b64_tr_b16 v[168:169], v219 offset:4096
	ds_read_b64_tr_b16 v[170:171], v219 offset:5120
	buffer_load_dwordx4 v[8:11], v2, s[16:19], s89 offen offset:1024
	s_waitcnt lgkmcnt(6)
	v_mfma_f32_32x32x16_bf16 v[116:131], v[156:159], v[96:99], v[116:131]
	ds_read_b64_tr_b16 v[172:173], v218 offset:6144
	ds_read_b64_tr_b16 v[174:175], v218 offset:7168
	buffer_load_dwordx4 v[12:15], v2, s[16:19], s89 offen offset:2048
	s_waitcnt lgkmcnt(6)
	v_mfma_f32_32x32x16_bf16 v[132:147], v[160:163], v[96:99], v[132:147]
	ds_read_b64_tr_b16 v[176:177], v219 offset:6144
	ds_read_b64_tr_b16 v[178:179], v219 offset:7168
	buffer_load_dwordx4 v[16:19], v2, s[16:19], s89 offen offset:3072
	s_barrier
	s_waitcnt lgkmcnt(6)
	v_mfma_f32_32x32x16_bf16 v[116:131], v[164:167], v[100:103], v[116:131]
	s_lshr_b32 s32, s54, 1
	s_mul_i32 s32, s32, 0xffff8000
	s_add_u32 s32, s32, 0xfffe8000
	v_add_u32 v218, s32, v218
	v_add_u32 v219, s32, v219
	ds_read_b64_tr_b16 v[148:149], v218 offset:0
	ds_read_b64_tr_b16 v[150:151], v218 offset:1024
	s_add_u32 m0, s30, 65536
	s_add_u32 s81, s5, 50176
	buffer_load_dwordx4 v3, s[72:75], s81 offen lds
	s_waitcnt lgkmcnt(6)
	v_mfma_f32_32x32x16_bf16 v[132:147], v[168:171], v[100:103], v[132:147]
	ds_read_b64_tr_b16 v[152:153], v219 offset:0
	ds_read_b64_tr_b16 v[154:155], v219 offset:1024
	s_add_u32 m0, s30, 73728
	s_add_u32 s81, s5, 150528
	buffer_load_dwordx4 v3, s[72:75], s81 offen lds
	s_waitcnt lgkmcnt(6)
	v_mfma_f32_32x32x16_bf16 v[116:131], v[172:175], v[104:107], v[116:131]
	ds_read_b64_tr_b16 v[156:157], v218 offset:2048
	ds_read_b64_tr_b16 v[158:159], v218 offset:3072
	s_add_u32 m0, s30, 81920
	s_add_u32 s81, s5, 250880
	buffer_load_dwordx4 v3, s[72:75], s81 offen lds
	s_waitcnt lgkmcnt(6)
	v_mfma_f32_32x32x16_bf16 v[132:147], v[176:179], v[104:107], v[132:147]
	ds_read_b64_tr_b16 v[160:161], v219 offset:2048
	ds_read_b64_tr_b16 v[162:163], v219 offset:3072
	s_add_u32 m0, s30, 90112
	s_add_u32 s81, s5, 351232
	buffer_load_dwordx4 v3, s[72:75], s81 offen lds
	s_waitcnt lgkmcnt(6)
	v_mfma_f32_32x32x16_bf16 v[116:131], v[148:151], v[36:39], v[116:131]
	ds_read_b64_tr_b16 v[164:165], v218 offset:4096
	ds_read_b64_tr_b16 v[166:167], v218 offset:5120
	s_add_u32 s82, s89, 4096
	buffer_load_dwordx4 v[60:63], v2, s[16:19], s82 offen offset:0
	s_waitcnt lgkmcnt(6)
	v_mfma_f32_32x32x16_bf16 v[132:147], v[152:155], v[36:39], v[132:147]
	ds_read_b64_tr_b16 v[168:169], v219 offset:4096
	ds_read_b64_tr_b16 v[170:171], v219 offset:5120
	buffer_load_dwordx4 v[64:67], v2, s[16:19], s82 offen offset:1024
	s_waitcnt lgkmcnt(6)
	v_mfma_f32_32x32x16_bf16 v[116:131], v[156:159], v[40:43], v[116:131]
	ds_read_b64_tr_b16 v[172:173], v218 offset:6144
	ds_read_b64_tr_b16 v[174:175], v218 offset:7168
	buffer_load_dwordx4 v[68:71], v2, s[16:19], s82 offen offset:2048
	s_waitcnt lgkmcnt(6)
	v_mfma_f32_32x32x16_bf16 v[132:147], v[160:163], v[40:43], v[132:147]
	ds_read_b64_tr_b16 v[176:177], v219 offset:6144
	ds_read_b64_tr_b16 v[178:179], v219 offset:7168
	buffer_load_dwordx4 v[72:75], v2, s[16:19], s82 offen offset:3072
	s_barrier
	s_waitcnt lgkmcnt(6)
	v_mfma_f32_32x32x16_bf16 v[116:131], v[164:167], v[44:47], v[116:131]
	ds_read_b64_tr_b16 v[148:149], v218 offset:32768
	ds_read_b64_tr_b16 v[150:151], v218 offset:33792
	s_waitcnt lgkmcnt(6)
	v_mfma_f32_32x32x16_bf16 v[132:147], v[168:171], v[44:47], v[132:147]
	ds_read_b64_tr_b16 v[152:153], v219 offset:32768
	ds_read_b64_tr_b16 v[154:155], v219 offset:33792
	s_waitcnt lgkmcnt(6)
	v_mfma_f32_32x32x16_bf16 v[116:131], v[172:175], v[48:51], v[116:131]
	ds_read_b64_tr_b16 v[156:157], v218 offset:34816
	ds_read_b64_tr_b16 v[158:159], v218 offset:35840
	s_waitcnt lgkmcnt(6)
	v_mfma_f32_32x32x16_bf16 v[132:147], v[176:179], v[48:51], v[132:147]
	ds_read_b64_tr_b16 v[160:161], v219 offset:34816
	ds_read_b64_tr_b16 v[162:163], v219 offset:35840
	s_waitcnt lgkmcnt(6)
	v_mfma_f32_32x32x16_bf16 v[116:131], v[148:151], v[52:55], v[116:131]
	ds_read_b64_tr_b16 v[164:165], v218 offset:36864
	ds_read_b64_tr_b16 v[166:167], v218 offset:37888
	s_waitcnt lgkmcnt(6)
	v_mfma_f32_32x32x16_bf16 v[132:147], v[152:155], v[52:55], v[132:147]
	ds_read_b64_tr_b16 v[168:169], v219 offset:36864
	ds_read_b64_tr_b16 v[170:171], v219 offset:37888
	s_waitcnt lgkmcnt(6)
	v_mfma_f32_32x32x16_bf16 v[116:131], v[156:159], v[56:59], v[116:131]
	ds_read_b64_tr_b16 v[172:173], v218 offset:38912
	ds_read_b64_tr_b16 v[174:175], v218 offset:39936
	s_waitcnt lgkmcnt(6)
	v_mfma_f32_32x32x16_bf16 v[132:147], v[160:163], v[56:59], v[132:147]
	ds_read_b64_tr_b16 v[176:177], v219 offset:38912
	ds_read_b64_tr_b16 v[178:179], v219 offset:39936
	s_waitcnt vmcnt(12)
	s_barrier
	s_waitcnt lgkmcnt(6)
	v_mfma_f32_32x32x16_bf16 v[116:131], v[164:167], v[108:111], v[116:131]
	v_add_u32 v218, 0x1c000, v218
	v_add_u32 v219, 0x1c000, v219
	ds_read_b64_tr_b16 v[148:149], v218 offset:0
	ds_read_b64_tr_b16 v[150:151], v218 offset:1024
	s_waitcnt lgkmcnt(6)
	v_mfma_f32_32x32x16_bf16 v[132:147], v[168:171], v[108:111], v[132:147]
	ds_read_b64_tr_b16 v[152:153], v219 offset:0
	ds_read_b64_tr_b16 v[154:155], v219 offset:1024
	s_waitcnt lgkmcnt(6)
	v_mfma_f32_32x32x16_bf16 v[116:131], v[172:175], v[112:115], v[116:131]
	ds_read_b64_tr_b16 v[156:157], v218 offset:2048
	ds_read_b64_tr_b16 v[158:159], v218 offset:3072
	s_waitcnt lgkmcnt(6)
	v_mfma_f32_32x32x16_bf16 v[132:147], v[176:179], v[112:115], v[132:147]
	ds_read_b64_tr_b16 v[160:161], v219 offset:2048
	ds_read_b64_tr_b16 v[162:163], v219 offset:3072
	s_waitcnt vmcnt(11) lgkmcnt(6)
	v_mfma_f32_32x32x16_bf16 v[116:131], v[148:151], v[4:7], v[116:131]
	ds_read_b64_tr_b16 v[164:165], v218 offset:4096
	ds_read_b64_tr_b16 v[166:167], v218 offset:5120
	s_waitcnt lgkmcnt(6)
	v_mfma_f32_32x32x16_bf16 v[132:147], v[152:155], v[4:7], v[132:147]
	ds_read_b64_tr_b16 v[168:169], v219 offset:4096
	ds_read_b64_tr_b16 v[170:171], v219 offset:5120
	s_waitcnt vmcnt(10) lgkmcnt(6)
	v_mfma_f32_32x32x16_bf16 v[116:131], v[156:159], v[8:11], v[116:131]
	ds_read_b64_tr_b16 v[172:173], v218 offset:6144
	ds_read_b64_tr_b16 v[174:175], v218 offset:7168
	s_waitcnt lgkmcnt(6)
	v_mfma_f32_32x32x16_bf16 v[132:147], v[160:163], v[8:11], v[132:147]
	ds_read_b64_tr_b16 v[176:177], v219 offset:6144
	ds_read_b64_tr_b16 v[178:179], v219 offset:7168
	s_waitcnt vmcnt(4)
	s_waitcnt lgkmcnt(0)
	s_barrier
	v_mfma_f32_32x32x16_bf16 v[116:131], v[164:167], v[12:15], v[116:131]
	v_add_u32 v218, 0xffff4000, v218
	v_add_u32 v219, 0xffff4000, v219
	ds_read_b64_tr_b16 v[148:149], v218 offset:0
	ds_read_b64_tr_b16 v[150:151], v218 offset:1024
	v_mfma_f32_32x32x16_bf16 v[132:147], v[168:171], v[12:15], v[132:147]
	ds_read_b64_tr_b16 v[152:153], v219 offset:0
	ds_read_b64_tr_b16 v[154:155], v219 offset:1024
	v_mfma_f32_32x32x16_bf16 v[116:131], v[172:175], v[16:19], v[116:131]
	ds_read_b64_tr_b16 v[156:157], v218 offset:2048
	ds_read_b64_tr_b16 v[158:159], v218 offset:3072
	v_mfma_f32_32x32x16_bf16 v[132:147], v[176:179], v[16:19], v[132:147]
	ds_read_b64_tr_b16 v[160:161], v219 offset:2048
	ds_read_b64_tr_b16 v[162:163], v219 offset:3072
	s_waitcnt vmcnt(3) lgkmcnt(6)
	v_mfma_f32_32x32x16_bf16 v[116:131], v[148:151], v[60:63], v[116:131]
	ds_read_b64_tr_b16 v[164:165], v218 offset:4096
	ds_read_b64_tr_b16 v[166:167], v218 offset:5120
	s_waitcnt lgkmcnt(6)
	v_mfma_f32_32x32x16_bf16 v[132:147], v[152:155], v[60:63], v[132:147]
	ds_read_b64_tr_b16 v[168:169], v219 offset:4096
	ds_read_b64_tr_b16 v[170:171], v219 offset:5120
	s_waitcnt vmcnt(2) lgkmcnt(6)
	v_mfma_f32_32x32x16_bf16 v[116:131], v[156:159], v[64:67], v[116:131]
	ds_read_b64_tr_b16 v[172:173], v218 offset:6144
	ds_read_b64_tr_b16 v[174:175], v218 offset:7168
	s_waitcnt lgkmcnt(6)
	v_mfma_f32_32x32x16_bf16 v[132:147], v[160:163], v[64:67], v[132:147]
	ds_read_b64_tr_b16 v[176:177], v219 offset:6144
	ds_read_b64_tr_b16 v[178:179], v219 offset:7168
	s_waitcnt vmcnt(1) lgkmcnt(6)
	v_mfma_f32_32x32x16_bf16 v[116:131], v[164:167], v[68:71], v[116:131]
	s_waitcnt lgkmcnt(4)
	v_mfma_f32_32x32x16_bf16 v[132:147], v[168:171], v[68:71], v[132:147]
	s_waitcnt vmcnt(0) lgkmcnt(2)
	v_mfma_f32_32x32x16_bf16 v[116:131], v[172:175], v[72:75], v[116:131]
	s_waitcnt lgkmcnt(0)
	v_mfma_f32_32x32x16_bf16 v[132:147], v[176:179], v[72:75], v[132:147]
	s_nop 9
	ds_write_b128 v223, v[116:119] offset:0
	ds_write_b128 v223, v[120:123] offset:32
	ds_write_b128 v223, v[124:127] offset:64
	ds_write_b128 v223, v[128:131] offset:96
	ds_write_b128 v223, v[132:135] offset:128
	ds_write_b128 v223, v[136:139] offset:160
	ds_write_b128 v223, v[140:143] offset:192
	ds_write_b128 v223, v[144:147] offset:224
	v_add_u32 v226, 98304, v224
	s_waitcnt lgkmcnt(0)
	s_barrier
	ds_read_b128 v[148:151], v224 offset:0
	ds_read_b128 v[152:155], v224 offset:16
	ds_read_b128 v[156:159], v224 offset:17408
	ds_read_b128 v[160:163], v224 offset:17424
	ds_read_b128 v[164:167], v226 offset:0
	ds_read_b128 v[168:171], v226 offset:16
	ds_read_b128 v[172:175], v226 offset:17408
	ds_read_b128 v[176:179], v226 offset:17424
	v_lshlrev_b32 v116, 16, v184
	v_and_b32 v117, 0xffff0000, v184
	v_lshlrev_b32 v118, 16, v185
	v_and_b32 v119, 0xffff0000, v185
	v_lshlrev_b32 v120, 16, v186
	v_and_b32 v121, 0xffff0000, v186
	v_lshlrev_b32 v122, 16, v187
	v_and_b32 v123, 0xffff0000, v187
	v_mov_b32 v225, 0x3f317218
	s_waitcnt lgkmcnt(5)
	v_add_f32 v148, v148, v156
	v_add_f32 v149, v149, v157
	v_add_f32 v150, v150, v158
	v_add_f32 v151, v151, v159
	s_waitcnt lgkmcnt(4)
	v_add_f32 v152, v152, v160
	v_add_f32 v153, v153, v161
	v_add_f32 v154, v154, v162
	v_add_f32 v155, v155, v163
	s_waitcnt lgkmcnt(1)
	v_add_f32 v164, v164, v172
	v_add_f32 v165, v165, v173
	v_add_f32 v166, v166, v174
	v_add_f32 v167, v167, v175
	s_waitcnt lgkmcnt(0)
	v_add_f32 v168, v168, v176
	v_add_f32 v169, v169, v177
	v_add_f32 v170, v170, v178
	v_add_f32 v171, v171, v179
	v_add_f32 v148, v148, v164
	v_add_f32 v149, v149, v165
	v_add_f32 v150, v150, v166
	v_add_f32 v151, v151, v167
	v_add_f32 v152, v152, v168
	v_add_f32 v153, v153, v169
	v_add_f32 v154, v154, v170
	v_add_f32 v155, v155, v171
	v_fmac_f32 v116, v148, v225
	v_fmac_f32 v117, v149, v225
	v_fmac_f32 v118, v150, v225
	v_fmac_f32 v119, v151, v225
	v_fmac_f32 v120, v152, v225
	v_fmac_f32 v121, v153, v225
	v_fmac_f32 v122, v154, v225
	v_fmac_f32 v123, v155, v225
	v_cvt_pk_bf16_f32 v148, v116, v117
	v_cvt_pk_bf16_f32 v149, v118, v119
	v_cvt_pk_bf16_f32 v150, v120, v121
	v_cvt_pk_bf16_f32 v151, v122, v123
	buffer_store_dwordx4 v[148:151], v220, s[76:79], s94 offen
	s_endpgm
parallel_sum__linear_kernel_hedgehog__dense_activation_mish__prompt_kernel_idle:
	s_waitcnt vmcnt(0)
	s_add_u32 s53, s100, 4
	v_mov_b32 v228, s53
	s_mov_b32 exec_hi, 0
	buffer_store_dword v228, v232, s[16:19], s101 offen sc1
	s_mov_b64 exec, -1
	s_waitcnt vmcnt(0)
	s_endpgm
parallel_sum__linear_kernel_hedgehog__dense_activation_mish__prompt_kernel_ffn:
	s_mov_b32 s20, s62
	s_and_b32 s21, s63, 0xffff
	s_mov_b32 s22, 0xe00
	s_mov_b32 s23, 0x00020000
	s_mov_b32 s16, s98
	s_and_b32 s17, s99, 0xffff
	s_mov_b32 s18, 0xb00000
	s_mov_b32 s19, 0x00020000
	s_mov_b32 s68, s64
	s_and_b32 s69, s65, 0xffff
	s_mov_b32 s70, 0x188000
	s_mov_b32 s71, 0x00020000
	s_mov_b32 s72, s58
	s_and_b32 s73, s59, 0xffff
	s_mov_b32 s74, 0x62000
	s_mov_b32 s75, 0x00020000
	s_mov_b32 s76, s66
	s_and_b32 s77, s67, 0xffff
	s_mov_b32 s78, 0x1c0000
	s_mov_b32 s79, 0x00020000
	s_and_b32 s25, s24, 3
	s_lshr_b32 s26, s24, 2
	s_lshl_b32 s50, s26, 1
	s_xor_b32 s50, s50, s25
	v_lshrrev_b32 v225, 5, v0
	s_lshl_b32 s33, s50, 1
	v_add_u32 v226, s33, v225
	v_bfe_u32 v227, v0, 1, 3
	v_xor_b32 v226, v226, v227
	v_lshlrev_b32 v226, 4, v226
	v_and_b32 v227, 31, v0
	v_lshl_add_u32 v226, v227, 7, v226
	s_lshl_b32 s33, s25, 12
	v_add_u32 v200, s33, v226
	v_xor_b32 v201, 32, v200
	v_xor_b32 v202, 64, v200
	v_xor_b32 v203, 96, v200
	v_lshlrev_b32 v2, 4, v0
	v_lshlrev_b32 v232, 2, v0
	v_lshlrev_b32 v231, 7, v0
	s_lshl_b32 s33, s26, 10
	s_add_u32 s33, s33, 155648
	v_add_u32 v224, s33, v2
	s_lshl_b32 s33, s25, 2
	v_add_u32 v223, s33, v224
	s_lshl_b32 s33, s25, 10
	s_add_u32 s33, s33, 159744
	v_lshlrev_b32 v227, 5, v227
	v_add_u32 v207, s33, v227
	s_lshl_b32 s33, s26, 4
	v_lshl_add_u32 v206, v225, 3, v207
	v_add_u32 v206, s33, v206
	v_mov_b32 v216, 0x3f803f80
	v_mov_b32 v217, 0x3f803f80
	v_mov_b32 v187, 0
	s_mov_b32 s42, 0x22222222
	s_mov_b32 s43, 0x22222222
	s_mov_b32 s44, 0xcccccccc
	s_mov_b32 s45, 0xcccccccc
	s_mov_b32 s46, 0x88888888
	s_mov_b32 s47, 0x88888888
	s_mov_b32 s48, 0
	s_mov_b32 s49, -1
	s_mov_b32 s51, 0x3b124925
	s_mul_i32 s32, s28, 7
	s_and_b32 s33, s28, 1
	s_add_u32 s34, s32, s33
	s_lshl_b32 s37, s34, 6
	s_add_u32 s38, s37, 256
	s_add_u32 s37, s37, 128
	s_mul_i32 s33, s33, 6
	s_sub_u32 s32, s32, s33
	s_add_u32 s32, s32, 6
	s_lshl_b32 s39, s32, 6
	v_and_b32 v227, 31, v0
	v_lshlrev_b32 v227, 1, v227
	s_add_u32 s34, s34, s26
	s_lshl_b32 s33, s34, 6
	buffer_load_ushort v233, v227, s[20:23], s33 offen offset:0
	buffer_load_ushort v234, v227, s[20:23], s33 offen offset:128
	buffer_load_ushort v235, v227, s[20:23], s33 offen offset:256
	buffer_load_ushort v236, v227, s[20:23], s39 offen
	v_lshrrev_b32 v225, 3, v0
	v_and_b32 v226, 7, v0
	v_lshrrev_b32 v227, 2, v0
	v_and_b32 v227, 4, v227
	v_xor_b32 v226, v226, v227
	s_lshl_b32 s33, s26, 6
	s_lshl_b32 s35, s25, 3
	s_add_u32 s33, s33, s35
	v_add_u32 v225, s33, v225
	v_lshrrev_b32 v227, 2, v226
	v_lshl_add_u32 v225, v227, 5, v225
	v_and_b32 v227, 3, v226
	v_lshlrev_b32 v227, 4, v227
	v_mad_u32_u24 v3, v225, s3, v227
	s_lshl_b32 s33, s27, 2
	s_add_u32 s33, s33, s25
	s_lshl_b32 s101, s33, 12
	s_mul_i32 s33, s33, 144
	s_add_u32 s33, s33, 2048
	s_lshl_b32 s34, s34, 1
	s_add_u32 s40, s33, s34
	s_lshl_b32 s40, s40, 10
	s_lshl_b32 s32, s32, 1
	s_add_u32 s32, s32, s26
	s_add_u32 s41, s33, s32
	s_lshl_b32 s41, s41, 10
	s_lshl_b32 s32, s28, 1
	s_add_u32 s32, s32, s26
	s_lshl_b32 s32, s32, 7
	s_add_u32 s101, s101, s32
	s_add_u32 s101, s101, 2048
	v_and_b32 v227, 3, v0
	v_lshlrev_b32 v227, 3, v227
	v_bfe_u32 v228, v0, 4, 1
	v_lshl_add_u32 v227, v228, 5, v227
	s_lshl_b32 s32, s26, 6
	v_add_u32 v238, s32, v227
	v_lshrrev_b32 v225, 5, v0
	v_lshlrev_b32 v225, 10, v225
	v_bfe_u32 v226, v0, 2, 2
	v_lshl_add_u32 v225, v226, 7, v225
	v_lshlrev_b32 v226, 3, v0
	v_and_b32 v226, 64, v226
	v_xor_b32 v226, v226, v238
	v_add_u32 v225, v225, v226
	s_lshl_b32 s33, s50, 11
	s_add_u32 s33, s33, 114688
	v_add_u32 v218, s33, v225
	v_xor_b32 v219, 2048, v218
	v_xor_b32 v220, 4096, v218
	v_xor_b32 v221, 6144, v218
	s_lshr_b32 s32, s50, 1
	s_lshl_b32 s32, s32, 6
	v_add_u32 v238, s32, v227
	s_and_b32 s32, s25, 1
	v_lshrrev_b32 v225, 5, v0
	v_lshlrev_b32 v225, 10, v225
	v_bfe_u32 v226, v0, 2, 2
	v_lshl_add_u32 v225, v226, 7, v225
	v_lshlrev_b32 v226, 3, v0
	v_and_b32 v226, 64, v226
	v_xor_b32 v226, v226, v238
	v_add_u32 v225, v225, v226
	s_lshl_b32 s33, s32, 11
	s_add_u32 s33, s33, 114688
	v_add_u32 v237, s33, v225
	v_xor_b32 v238, 2048, v237
	s_add_u32 m0, s29, 16256
	s_nop 0
	buffer_load_dwordx4 v204, s[8:11], s31 offen offset:128 lds
	s_add_u32 m0, s29, 17280
	s_nop 0
	buffer_load_dwordx4 v205, s[8:11], s31 offen offset:128 lds
	s_add_u32 m0, s30, 122880
	s_nop 0
	buffer_load_dwordx4 v1, s[12:15], s36 offen lds
	s_add_u32 s36, s36, s93
	s_add_u32 m0, s29, 32512
	s_nop 0
	buffer_load_dwordx4 v204, s[8:11], s31 offen offset:256 lds
	s_add_u32 m0, s29, 33536
	s_nop 0
	buffer_load_dwordx4 v205, s[8:11], s31 offen offset:256 lds
	s_add_u32 m0, s30, 147456
	s_nop 0
	buffer_load_dwordx4 v1, s[12:15], s36 offen lds
	s_add_u32 s36, s36, s93
	s_add_u32 m0, s29, 48768
	s_nop 0
	buffer_load_dwordx4 v204, s[8:11], s31 offen offset:384 lds
	s_add_u32 m0, s29, 49792
	s_nop 0
	buffer_load_dwordx4 v205, s[8:11], s31 offen offset:384 lds
	s_add_u32 m0, s30, 131072
	s_nop 0
	buffer_load_dwordx4 v1, s[12:15], s36 offen lds
	s_add_u32 s36, s36, s93
	s_waitcnt vmcnt(13)
	s_barrier
	ds_read_b128 v[4:7], v200 offset:0
	ds_read_b64_tr_b16 v[148:149], v218 offset:0
	ds_read_b64_tr_b16 v[150:151], v218 offset:512
	s_add_u32 m0, s29, 65024
	s_nop 0
	buffer_load_dwordx4 v204, s[8:11], s31 offen offset:512 lds
	ds_read_b128 v[8:11], v201 offset:0
	ds_read_b64_tr_b16 v[152:153], v219 offset:0
	ds_read_b64_tr_b16 v[154:155], v219 offset:512
	s_add_u32 m0, s29, 66048
	s_nop 0
	buffer_load_dwordx4 v205, s[8:11], s31 offen offset:512 lds
	ds_read_b128 v[60:63], v202 offset:0
	ds_read_b64_tr_b16 v[156:157], v220 offset:0
	ds_read_b64_tr_b16 v[158:159], v220 offset:512
	s_add_u32 m0, s30, 139264
	s_nop 0
	buffer_load_dwordx4 v1, s[12:15], s36 offen lds
	s_add_u32 s36, s36, s93
	ds_read_b128 v[64:67], v203 offset:0
	ds_read_b64_tr_b16 v[160:161], v221 offset:0
	ds_read_b64_tr_b16 v[162:163], v221 offset:512
	s_waitcnt vmcnt(9)
	s_barrier
	s_waitcnt lgkmcnt(9)
	v_mfma_f32_32x32x16_bf16 v[116:131], v[148:151], v[4:7], 0
	ds_read_b128 v[12:15], v200 offset:16384
	ds_read_b64_tr_b16 v[164:165], v218 offset:8192
	ds_read_b64_tr_b16 v[166:167], v218 offset:8704
	s_add_u32 m0, s29, 81280
	s_nop 0
	buffer_load_dwordx4 v204, s[8:11], s31 offen offset:640 lds
	v_mfma_f32_4x4x4_16b_bf16 v[180:183], v[216:217], v[148:149], 0
	v_mfma_f32_4x4x4_16b_bf16 v[192:195], v[216:217], v[4:5], 0
	v_mfma_f32_4x4x4_16b_bf16 v[196:199], v[4:5], v[4:5], 0
	s_waitcnt lgkmcnt(9)
	v_mfma_f32_32x32x16_bf16 v[116:131], v[152:155], v[8:11], v[116:131]
	ds_read_b128 v[16:19], v201 offset:16384
	ds_read_b64_tr_b16 v[168:169], v219 offset:8192
	ds_read_b64_tr_b16 v[170:171], v219 offset:8704
	s_add_u32 m0, s29, 82304
	s_nop 0
	buffer_load_dwordx4 v205, s[8:11], s31 offen offset:640 lds
	v_mfma_f32_4x4x4_16b_bf16 v[180:183], v[216:217], v[150:151], v[180:183]
	v_mfma_f32_4x4x4_16b_bf16 v[192:195], v[216:217], v[8:9], v[192:195]
	v_mfma_f32_4x4x4_16b_bf16 v[196:199], v[8:9], v[8:9], v[196:199]
	s_waitcnt lgkmcnt(9)
	v_mfma_f32_32x32x16_bf16 v[116:131], v[156:159], v[60:63], v[116:131]
	ds_read_b128 v[68:71], v202 offset:16384
	ds_read_b64_tr_b16 v[172:173], v220 offset:8192
	ds_read_b64_tr_b16 v[174:175], v220 offset:8704
	v_mfma_f32_4x4x4_16b_bf16 v[192:195], v[216:217], v[6:7], v[192:195]
	v_mfma_f32_4x4x4_16b_bf16 v[196:199], v[6:7], v[6:7], v[196:199]
	s_waitcnt lgkmcnt(9)
	v_mfma_f32_32x32x16_bf16 v[116:131], v[160:163], v[64:67], v[116:131]
	ds_read_b128 v[72:75], v203 offset:16384
	ds_read_b64_tr_b16 v[176:177], v221 offset:8192
	ds_read_b64_tr_b16 v[178:179], v221 offset:8704
	v_mfma_f32_4x4x4_16b_bf16 v[192:195], v[216:217], v[10:11], v[192:195]
	v_mfma_f32_4x4x4_16b_bf16 v[196:199], v[10:11], v[10:11], v[196:199]
	s_waitcnt vmcnt(8)
	s_barrier
	s_waitcnt lgkmcnt(9)
	v_mfma_f32_32x32x16_bf16 v[116:131], v[164:167], v[12:15], v[116:131]
	ds_read_b128 v[20:23], v200 offset:32768
	ds_read_b64_tr_b16 v[148:149], v218 offset:32768
	ds_read_b64_tr_b16 v[150:151], v218 offset:33280
	s_add_u32 m0, s30, 114688
	s_nop 0
	buffer_load_dwordx4 v1, s[12:15], s36 offen lds
	s_add_u32 s36, s36, s93
	v_mfma_f32_4x4x4_16b_bf16 v[180:183], v[216:217], v[164:165], v[180:183]
	v_mfma_f32_4x4x4_16b_bf16 v[192:195], v[216:217], v[12:13], v[192:195]
	v_mfma_f32_4x4x4_16b_bf16 v[196:199], v[12:13], v[12:13], v[196:199]
	s_waitcnt lgkmcnt(9)
	v_mfma_f32_32x32x16_bf16 v[116:131], v[168:171], v[16:19], v[116:131]
	ds_read_b128 v[24:27], v201 offset:32768
	ds_read_b64_tr_b16 v[152:153], v219 offset:32768
	ds_read_b64_tr_b16 v[154:155], v219 offset:33280
	s_add_u32 m0, s29, 97536
	s_nop 0
	buffer_load_dwordx4 v204, s[8:11], s31 offen offset:768 lds
	v_mfma_f32_4x4x4_16b_bf16 v[180:183], v[216:217], v[166:167], v[180:183]
	v_mfma_f32_4x4x4_16b_bf16 v[192:195], v[216:217], v[16:17], v[192:195]
	v_mfma_f32_4x4x4_16b_bf16 v[196:199], v[16:17], v[16:17], v[196:199]
	s_waitcnt lgkmcnt(9)
	v_mfma_f32_32x32x16_bf16 v[116:131], v[172:175], v[68:71], v[116:131]
	ds_read_b128 v[76:79], v202 offset:32768
	ds_read_b64_tr_b16 v[156:157], v220 offset:32768
	ds_read_b64_tr_b16 v[158:159], v220 offset:33280
	s_add_u32 m0, s29, 98560
	s_nop 0
	buffer_load_dwordx4 v205, s[8:11], s31 offen offset:768 lds
	v_mov_b32 v229, 0
	global_load_dword v229, v229, s[96:97] sc1
	v_mfma_f32_4x4x4_16b_bf16 v[192:195], v[216:217], v[14:15], v[192:195]
	v_mfma_f32_4x4x4_16b_bf16 v[196:199], v[14:15], v[14:15], v[196:199]
	s_waitcnt lgkmcnt(9)
	v_mfma_f32_32x32x16_bf16 v[116:131], v[176:179], v[72:75], v[116:131]
	ds_read_b128 v[80:83], v203 offset:32768
	ds_read_b64_tr_b16 v[160:161], v221 offset:32768
	ds_read_b64_tr_b16 v[162:163], v221 offset:33280
	v_mfma_f32_4x4x4_16b_bf16 v[192:195], v[216:217], v[18:19], v[192:195]
	v_mfma_f32_4x4x4_16b_bf16 v[196:199], v[18:19], v[18:19], v[196:199]
	s_waitcnt vmcnt(9)
	s_barrier
	s_waitcnt lgkmcnt(9)
	v_mfma_f32_32x32x16_bf16 v[116:131], v[148:151], v[20:23], v[116:131]
	ds_read_b128 v[28:31], v200 offset:49152
	ds_read_b64_tr_b16 v[164:165], v218 offset:16384
	ds_read_b64_tr_b16 v[166:167], v218 offset:16896
	s_add_u32 m0, s30, 122880
	s_nop 0
	buffer_load_dwordx4 v1, s[12:15], s36 offen lds
	s_add_u32 s36, s36, s93
	v_mfma_f32_4x4x4_16b_bf16 v[180:183], v[216:217], v[148:149], v[180:183]
	v_mfma_f32_4x4x4_16b_bf16 v[192:195], v[216:217], v[20:21], v[192:195]
	v_mfma_f32_4x4x4_16b_bf16 v[196:199], v[20:21], v[20:21], v[196:199]
	s_waitcnt lgkmcnt(9)
	v_mfma_f32_32x32x16_bf16 v[116:131], v[152:155], v[24:27], v[116:131]
	ds_read_b128 v[32:35], v201 offset:49152
	ds_read_b64_tr_b16 v[168:169], v219 offset:16384
	ds_read_b64_tr_b16 v[170:171], v219 offset:16896
	s_add_u32 m0, s30, 0
	s_nop 0
	buffer_load_dwordx4 v1, s[12:15], s37 offen lds
	s_add_u32 s37, s37, s93
	v_mfma_f32_4x4x4_16b_bf16 v[180:183], v[216:217], v[150:151], v[180:183]
	v_mfma_f32_4x4x4_16b_bf16 v[192:195], v[216:217], v[24:25], v[192:195]
	v_mfma_f32_4x4x4_16b_bf16 v[196:199], v[24:25], v[24:25], v[196:199]
	v_add_u32 v200, 0x10000, v200
	s_waitcnt lgkmcnt(9)
	v_mfma_f32_32x32x16_bf16 v[116:131], v[156:159], v[76:79], v[116:131]
	ds_read_b128 v[84:87], v202 offset:49152
	ds_read_b64_tr_b16 v[172:173], v220 offset:16384
	ds_read_b64_tr_b16 v[174:175], v220 offset:16896
	s_add_u32 m0, s30, 8192
	s_nop 0
	buffer_load_dwordx4 v1, s[12:15], s37 offen lds
	s_add_u32 s37, s37, s93
	v_mfma_f32_4x4x4_16b_bf16 v[192:195], v[216:217], v[22:23], v[192:195]
	v_mfma_f32_4x4x4_16b_bf16 v[196:199], v[22:23], v[22:23], v[196:199]
	v_add_u32 v201, 0x10000, v201
	s_waitcnt lgkmcnt(9)
	v_mfma_f32_32x32x16_bf16 v[116:131], v[160:163], v[80:83], v[116:131]
	ds_read_b128 v[88:91], v203 offset:49152
	ds_read_b64_tr_b16 v[176:177], v221 offset:16384
	ds_read_b64_tr_b16 v[178:179], v221 offset:16896
	v_mfma_f32_4x4x4_16b_bf16 v[192:195], v[216:217], v[26:27], v[192:195]
	v_mfma_f32_4x4x4_16b_bf16 v[196:199], v[26:27], v[26:27], v[196:199]
	v_add_u32 v202, 0x10000, v202
	s_waitcnt vmcnt(9)
	s_barrier
	s_waitcnt lgkmcnt(9)
	v_mfma_f32_32x32x16_bf16 v[116:131], v[164:167], v[28:31], v[116:131]
	ds_read_b128 v[36:39], v200 offset:0
	ds_read_b64_tr_b16 v[148:149], v218 offset:24576
	ds_read_b64_tr_b16 v[150:151], v218 offset:25088
	s_add_u32 m0, s30, 16384
	s_nop 0
	buffer_load_dwordx4 v1, s[12:15], s37 offen lds
	s_add_u32 s37, s37, s93
	v_mfma_f32_4x4x4_16b_bf16 v[180:183], v[216:217], v[164:165], v[180:183]
	v_mfma_f32_4x4x4_16b_bf16 v[192:195], v[216:217], v[28:29], v[192:195]
	v_mfma_f32_4x4x4_16b_bf16 v[196:199], v[28:29], v[28:29], v[196:199]
	v_add_u32 v203, 0x10000, v203
	s_waitcnt lgkmcnt(9)
	v_mfma_f32_32x32x16_bf16 v[116:131], v[168:171], v[32:35], v[116:131]
	ds_read_b128 v[40:43], v201 offset:0
	ds_read_b64_tr_b16 v[152:153], v219 offset:24576
	ds_read_b64_tr_b16 v[154:155], v219 offset:25088
	v_mfma_f32_4x4x4_16b_bf16 v[180:183], v[216:217], v[166:167], v[180:183]
	v_mfma_f32_4x4x4_16b_bf16 v[192:195], v[216:217], v[32:33], v[192:195]
	v_mfma_f32_4x4x4_16b_bf16 v[196:199], v[32:33], v[32:33], v[196:199]
	s_waitcnt lgkmcnt(9)
	v_mfma_f32_32x32x16_bf16 v[116:131], v[172:175], v[84:87], v[116:131]
	ds_read_b128 v[92:95], v202 offset:0
	ds_read_b64_tr_b16 v[156:157], v220 offset:24576
	ds_read_b64_tr_b16 v[158:159], v220 offset:25088
	s_add_u32 m0, s30, 24576
	s_nop 0
	buffer_load_dwordx4 v1, s[12:15], s37 offen lds
	s_add_u32 s37, s37, s93
	v_mfma_f32_4x4x4_16b_bf16 v[192:195], v[216:217], v[30:31], v[192:195]
	v_mfma_f32_4x4x4_16b_bf16 v[196:199], v[30:31], v[30:31], v[196:199]
	s_waitcnt lgkmcnt(9)
	v_mfma_f32_32x32x16_bf16 v[116:131], v[176:179], v[88:91], v[116:131]
	ds_read_b128 v[96:99], v203 offset:0
	ds_read_b64_tr_b16 v[160:161], v221 offset:24576
	ds_read_b64_tr_b16 v[162:163], v221 offset:25088
	v_mfma_f32_4x4x4_16b_bf16 v[192:195], v[216:217], v[34:35], v[192:195]
	v_mfma_f32_4x4x4_16b_bf16 v[196:199], v[34:35], v[34:35], v[196:199]
	s_waitcnt vmcnt(8)
	s_barrier
	s_waitcnt lgkmcnt(9)
	v_mfma_f32_32x32x16_bf16 v[116:131], v[148:151], v[36:39], v[116:131]
	ds_read_b128 v[44:47], v200 offset:16384
	ds_read_b64_tr_b16 v[164:165], v218 offset:0
	ds_read_b64_tr_b16 v[166:167], v218 offset:512
	s_add_u32 m0, s30, 32768
	s_nop 0
	buffer_load_dwordx4 v1, s[12:15], s37 offen lds
	s_add_u32 s37, s37, s93
	v_mfma_f32_4x4x4_16b_bf16 v[180:183], v[216:217], v[148:149], v[180:183]
	v_mfma_f32_4x4x4_16b_bf16 v[192:195], v[216:217], v[36:37], v[192:195]
	v_mfma_f32_4x4x4_16b_bf16 v[196:199], v[36:37], v[36:37], v[196:199]
	s_waitcnt lgkmcnt(9)
	v_mfma_f32_32x32x16_bf16 v[116:131], v[152:155], v[40:43], v[116:131]
	ds_read_b128 v[48:51], v201 offset:16384
	ds_read_b64_tr_b16 v[168:169], v219 offset:0
	ds_read_b64_tr_b16 v[170:171], v219 offset:512
	v_mfma_f32_4x4x4_16b_bf16 v[180:183], v[216:217], v[150:151], v[180:183]
	v_mfma_f32_4x4x4_16b_bf16 v[192:195], v[216:217], v[40:41], v[192:195]
	v_mfma_f32_4x4x4_16b_bf16 v[196:199], v[40:41], v[40:41], v[196:199]
	s_waitcnt lgkmcnt(9)
	v_mfma_f32_32x32x16_bf16 v[116:131], v[156:159], v[92:95], v[116:131]
	ds_read_b128 v[100:103], v202 offset:16384
	ds_read_b64_tr_b16 v[172:173], v220 offset:0
	ds_read_b64_tr_b16 v[174:175], v220 offset:512
	s_add_u32 m0, s30, 40960
	s_nop 0
	buffer_load_dwordx4 v1, s[12:15], s37 offen lds
	s_add_u32 s37, s37, s93
	v_mfma_f32_4x4x4_16b_bf16 v[192:195], v[216:217], v[38:39], v[192:195]
	v_mfma_f32_4x4x4_16b_bf16 v[196:199], v[38:39], v[38:39], v[196:199]
	s_waitcnt lgkmcnt(9)
	v_mfma_f32_32x32x16_bf16 v[116:131], v[160:163], v[96:99], v[116:131]
	ds_read_b128 v[104:107], v203 offset:16384
	ds_read_b64_tr_b16 v[176:177], v221 offset:0
	ds_read_b64_tr_b16 v[178:179], v221 offset:512
	v_mfma_f32_4x4x4_16b_bf16 v[192:195], v[216:217], v[42:43], v[192:195]
	v_mfma_f32_4x4x4_16b_bf16 v[196:199], v[42:43], v[42:43], v[196:199]
	s_waitcnt vmcnt(6)
	s_barrier
	s_waitcnt lgkmcnt(9)
	v_mfma_f32_32x32x16_bf16 v[116:131], v[164:167], v[44:47], v[116:131]
	ds_read_b128 v[52:55], v200 offset:32768
	ds_read_b64_tr_b16 v[148:149], v218 offset:8192
	ds_read_b64_tr_b16 v[150:151], v218 offset:8704
	s_add_u32 m0, s30, 49152
	s_nop 0
	buffer_load_dwordx4 v1, s[12:15], s37 offen lds
	s_add_u32 s37, s37, s93
	v_mfma_f32_4x4x4_16b_bf16 v[180:183], v[216:217], v[164:165], v[180:183]
	v_mfma_f32_4x4x4_16b_bf16 v[192:195], v[216:217], v[44:45], v[192:195]
	v_mfma_f32_4x4x4_16b_bf16 v[196:199], v[44:45], v[44:45], v[196:199]
	s_waitcnt lgkmcnt(9)
	v_mfma_f32_32x32x16_bf16 v[116:131], v[168:171], v[48:51], v[116:131]
	ds_read_b128 v[56:59], v201 offset:32768
	ds_read_b64_tr_b16 v[152:153], v219 offset:8192
	ds_read_b64_tr_b16 v[154:155], v219 offset:8704
	v_mfma_f32_4x4x4_16b_bf16 v[180:183], v[216:217], v[166:167], v[180:183]
	v_mfma_f32_4x4x4_16b_bf16 v[192:195], v[216:217], v[48:49], v[192:195]
	v_mfma_f32_4x4x4_16b_bf16 v[196:199], v[48:49], v[48:49], v[196:199]
	s_waitcnt lgkmcnt(4)
	v_mfma_f32_4x4x4_16b_bf16 v[180:183], v[216:217], v[148:149], v[180:183]
	v_add_u32 v218, 0xfffe4000, v218
	v_mfma_f32_32x32x16_bf16 v[116:131], v[172:175], v[100:103], v[116:131]
	ds_read_b128 v[108:111], v202 offset:32768
	ds_read_b64_tr_b16 v[156:157], v220 offset:8192
	ds_read_b64_tr_b16 v[158:159], v220 offset:8704
	s_add_u32 m0, s30, 57344
	s_nop 0
	buffer_load_dwordx4 v1, s[12:15], s38 offen lds
	s_add_u32 s38, s38, s93
	v_mfma_f32_4x4x4_16b_bf16 v[192:195], v[216:217], v[46:47], v[192:195]
	v_mfma_f32_4x4x4_16b_bf16 v[196:199], v[46:47], v[46:47], v[196:199]
	s_waitcnt lgkmcnt(6)
	v_mfma_f32_4x4x4_16b_bf16 v[180:183], v[216:217], v[150:151], v[180:183]
	v_mfma_f32_4x4x4_16b_bf16 v[192:195], v[216:217], v[52:53], v[192:195]
	v_mfma_f32_4x4x4_16b_bf16 v[196:199], v[52:53], v[52:53], v[196:199]
	s_nop 0
	v_mfma_f32_4x4x4_16b_bf16 v[192:195], v[216:217], v[54:55], v[192:195]
	v_mfma_f32_4x4x4_16b_bf16 v[196:199], v[54:55], v[54:55], v[196:199]
	v_add_u32 v219, 0xfffe4000, v219
	v_mfma_f32_32x32x16_bf16 v[116:131], v[176:179], v[104:107], v[116:131]
	ds_read_b128 v[112:115], v203 offset:32768
	ds_read_b64_tr_b16 v[160:161], v221 offset:8192
	ds_read_b64_tr_b16 v[162:163], v221 offset:8704
	v_mfma_f32_4x4x4_16b_bf16 v[192:195], v[216:217], v[50:51], v[192:195]
	v_mfma_f32_4x4x4_16b_bf16 v[196:199], v[50:51], v[50:51], v[196:199]
	s_waitcnt lgkmcnt(8)
	v_mfma_f32_4x4x4_16b_bf16 v[192:195], v[216:217], v[56:57], v[192:195]
	v_mfma_f32_4x4x4_16b_bf16 v[196:199], v[56:57], v[56:57], v[196:199]
	s_nop 0
	v_mfma_f32_4x4x4_16b_bf16 v[192:195], v[216:217], v[58:59], v[192:195]
	v_mfma_f32_4x4x4_16b_bf16 v[196:199], v[58:59], v[58:59], v[196:199]
	v_add_u32 v220, 0xfffe4000, v220
	s_nop 3
	v_cndmask_b32 v196, v196, v197, s[42:43]
	v_cndmask_b32 v198, v198, v199, s[46:47]
	v_cndmask_b32 v193, v196, v198, s[44:45]
	ds_write_b64 v206, v[192:193]
	ds_write_b32 v223, v180 offset:0
	s_waitcnt vmcnt(5)
	s_waitcnt lgkmcnt(0)
	s_barrier
	v_mfma_f32_32x32x16_bf16 v[116:131], v[148:151], v[52:55], v[116:131]
	ds_read_b64_tr_b16 v[164:165], v218 offset:0
	ds_read_b64_tr_b16 v[166:167], v218 offset:512
	s_add_u32 m0, s30, 65536
	s_nop 0
	buffer_load_dwordx4 v1, s[12:15], s38 offen lds
	s_add_u32 s38, s38, s93
	v_add_u32 v221, 0xfffe4000, v221
	ds_read_b128 v[208:211], v207
	ds_read_b128 v[212:215], v207 offset:16
	s_waitcnt lgkmcnt(1)
	v_add_f32 v208, v208, v210
	s_waitcnt lgkmcnt(0)
	v_add_f32 v212, v212, v214
	v_add_f32 v209, v209, v211
	v_mfma_f32_32x32x16_bf16 v[116:131], v[152:155], v[56:59], v[116:131]
	ds_read_b64_tr_b16 v[168:169], v219 offset:0
	ds_read_b64_tr_b16 v[170:171], v219 offset:512
	v_add_f32 v213, v213, v215
	v_add_f32 v208, v208, v212
	v_add_f32 v209, v209, v213
	v_mul_f32 v208, s51, v208
	v_mul_f32 v210, v208, v208
	v_fma_f32 v209, v209, s51, -v210
	v_max_f32 v209, 0, v209
	v_add_f32 v209, 0x3727c5ac, v209
	v_mfma_f32_32x32x16_bf16 v[116:131], v[156:159], v[108:111], v[116:131]
	ds_read_b64_tr_b16 v[172:173], v220 offset:0
	ds_read_b64_tr_b16 v[174:175], v220 offset:512
	s_add_u32 m0, s30, 73728
	s_nop 0
	buffer_load_dwordx4 v1, s[12:15], s38 offen lds
	s_add_u32 s38, s38, s93
	v_rsq_f32 v215, v209
	v_cvt_pk_bf16_f32 v210, v208, v208
	v_and_b32 v210, 0xffff0000, v210
	v_sub_f32 v210, v208, v210
	v_cvt_pk_bf16_f32 v188, v208, v210
	v_mfma_f32_32x32x16_bf16 v[116:131], v[160:163], v[112:115], v[116:131]
	ds_read_b64_tr_b16 v[176:177], v221 offset:0
	ds_read_b64_tr_b16 v[178:179], v221 offset:512
	v_mul_f32 v209, v209, v215
	v_mul_f32 v222, 0x3fb8aa3b, v215
	v_cndmask_b32 v209, v209, 0, s[48:49]
	v_cvt_pk_bf16_f32 v211, v209, v209
	v_and_b32 v211, 0xffff0000, v211
	v_sub_f32 v211, v209, v211
	v_cvt_pk_bf16_f32 v189, v208, v209
	v_cvt_pk_bf16_f32 v190, v211, 0
	v_mov_b32 v191, 0
	v_mfma_f32_32x32x16_bf16 v[132:147], v[164:167], v[4:7], 0
	ds_read_b64_tr_b16 v[148:149], v218 offset:8192
	ds_read_b64_tr_b16 v[150:151], v218 offset:8704
	s_add_u32 m0, s30, 81920
	s_nop 0
	buffer_load_dwordx4 v1, s[12:15], s38 offen lds
	s_add_u32 s38, s38, s93
	v_mfma_f32_4x4x4_16b_bf16 v[180:183], v[216:217], v[164:165], 0
	ds_read_b128 v[208:211], v224 offset:0
	s_waitcnt lgkmcnt(0)
	v_add_f32 v208, v208, v209
	v_add_f32 v210, v210, v211
	v_mfma_f32_32x32x16_bf16 v[132:147], v[168:171], v[8:11], v[132:147]
	ds_read_b64_tr_b16 v[152:153], v219 offset:8192
	ds_read_b64_tr_b16 v[154:155], v219 offset:8704
	v_mfma_f32_4x4x4_16b_bf16 v[180:183], v[216:217], v[166:167], v[180:183]
	v_add_f32 v208, v208, v210
	v_cvt_pk_bf16_f32 v184, -v208, -v208
	v_lshlrev_b32 v211, 16, v233
	v_and_b32 v210, 0xffff0000, v184
	v_add_f32 v210, v208, v210
	v_cvt_pk_bf16_f32 v185, -v210, v211
	v_mov_b32 v186, v233
	v_mfma_f32_32x32x16_bf16 v[132:147], v[172:175], v[60:63], v[132:147]
	ds_read_b64_tr_b16 v[156:157], v220 offset:8192
	ds_read_b64_tr_b16 v[158:159], v220 offset:8704
	s_add_u32 m0, s30, 90112
	s_nop 0
	buffer_load_dwordx4 v1, s[12:15], s38 offen lds
	s_add_u32 s38, s38, s93
	v_mfma_f32_32x32x16_bf16 v[116:131], v[184:187], v[188:191], v[116:131]
	v_mfma_f32_32x32x16_bf16 v[132:147], v[176:179], v[64:67], v[132:147]
	ds_read_b64_tr_b16 v[160:161], v221 offset:8192
	ds_read_b64_tr_b16 v[162:163], v221 offset:8704
	v_mfma_f32_32x32x16_bf16 v[132:147], v[148:151], v[12:15], v[132:147]
	ds_read_b64_tr_b16 v[164:165], v218 offset:16384
	ds_read_b64_tr_b16 v[166:167], v218 offset:16896
	s_add_u32 m0, s30, 98304
	s_nop 0
	buffer_load_dwordx4 v1, s[12:15], s38 offen lds
	s_add_u32 s38, s38, s93
	v_mfma_f32_4x4x4_16b_bf16 v[180:183], v[216:217], v[148:149], v[180:183]
	s_nop 0
	v_mul_f32 v116, v116, v222
	v_mul_f32 v117, v117, v222
	v_mul_f32 v118, v118, v222
	v_mul_f32 v119, v119, v222
	s_waitcnt lgkmcnt(6)
	v_mfma_f32_32x32x16_bf16 v[132:147], v[152:155], v[16:19], v[132:147]
	ds_read_b64_tr_b16 v[168:169], v219 offset:16384
	ds_read_b64_tr_b16 v[170:171], v219 offset:16896
	v_mfma_f32_4x4x4_16b_bf16 v[180:183], v[216:217], v[150:151], v[180:183]
	v_exp_f32 v208, v116
	v_exp_f32 v209, v117
	v_exp_f32 v210, v118
	v_exp_f32 v211, v119
	s_waitcnt lgkmcnt(6)
	v_mfma_f32_32x32x16_bf16 v[132:147], v[156:159], v[68:71], v[132:147]
	ds_read_b64_tr_b16 v[172:173], v220 offset:16384
	ds_read_b64_tr_b16 v[174:175], v220 offset:16896
	s_add_u32 m0, s30, 106496
	s_nop 0
	buffer_load_dwordx4 v1, s[12:15], s38 offen lds
	s_add_u32 s38, s38, s93
	v_fma_f32 v212, v208, -0.5, -1.0
	v_fma_f32 v213, v209, -0.5, -1.0
	v_fma_f32 v214, v210, -0.5, -1.0
	v_fma_f32 v215, v211, -0.5, -1.0
	v_fma_f32 v208, v208, v212, -1.0
	v_fma_f32 v209, v209, v213, -1.0
	s_waitcnt lgkmcnt(6)
	v_mfma_f32_32x32x16_bf16 v[132:147], v[160:163], v[72:75], v[132:147]
	ds_read_b64_tr_b16 v[176:177], v221 offset:16384
	ds_read_b64_tr_b16 v[178:179], v221 offset:16896
	v_fma_f32 v210, v210, v214, -1.0
	v_fma_f32 v211, v211, v215, -1.0
	v_rcp_f32 v208, v208
	v_rcp_f32 v209, v209
	v_rcp_f32 v210, v210
	v_rcp_f32 v211, v211
	s_waitcnt vmcnt(7)
	s_barrier
	s_waitcnt lgkmcnt(6)
	v_mfma_f32_32x32x16_bf16 v[132:147], v[164:167], v[20:23], v[132:147]
	ds_read_b64_tr_b16 v[148:149], v218 offset:24576
	ds_read_b64_tr_b16 v[150:151], v218 offset:25088
	s_add_u32 m0, s30, 131072
	s_nop 0
	buffer_load_dwordx4 v3, s[12:15], s39 offen lds
	s_add_u32 s39, s39, 458752
	v_mfma_f32_4x4x4_16b_bf16 v[180:183], v[216:217], v[164:165], v[180:183]
	v_fmac_f32 v116, v116, v208
	v_fmac_f32 v117, v117, v209
	v_fmac_f32 v118, v118, v210
	v_fmac_f32 v119, v119, v211
	s_waitcnt lgkmcnt(6)
	v_mfma_f32_32x32x16_bf16 v[132:147], v[168:171], v[24:27], v[132:147]
	ds_read_b64_tr_b16 v[152:153], v219 offset:24576
	ds_read_b64_tr_b16 v[154:155], v219 offset:25088
	v_mfma_f32_4x4x4_16b_bf16 v[180:183], v[216:217], v[166:167], v[180:183]
	v_cvt_pk_bf16_f32 v192, v116, v117
	v_cvt_pk_bf16_f32 v193, v118, v119
	v_mul_f32 v120, v120, v222
	v_mul_f32 v121, v121, v222
	v_mul_f32 v122, v122, v222
	v_mul_f32 v123, v123, v222
	v_exp_f32 v208, v120
	s_waitcnt lgkmcnt(6)
	v_mfma_f32_32x32x16_bf16 v[132:147], v[172:175], v[76:79], v[132:147]
	ds_read_b64_tr_b16 v[156:157], v220 offset:24576
	ds_read_b64_tr_b16 v[158:159], v220 offset:25088
	s_add_u32 m0, s30, 139264
	s_nop 0
	buffer_load_dwordx4 v3, s[12:15], s39 offen lds
	s_add_u32 s39, s39, 458752
	v_exp_f32 v209, v121
	v_exp_f32 v210, v122
	v_exp_f32 v211, v123
	s_waitcnt lgkmcnt(6)
	v_mfma_f32_32x32x16_bf16 v[132:147], v[176:179], v[80:83], v[132:147]
	ds_read_b64_tr_b16 v[160:161], v221 offset:24576
	ds_read_b64_tr_b16 v[162:163], v221 offset:25088
	v_fma_f32 v212, v208, -0.5, -1.0
	v_fma_f32 v213, v209, -0.5, -1.0
	v_fma_f32 v214, v210, -0.5, -1.0
	v_fma_f32 v215, v211, -0.5, -1.0
	v_fma_f32 v208, v208, v212, -1.0
	v_fma_f32 v209, v209, v213, -1.0
	v_fma_f32 v210, v210, v214, -1.0
	v_fma_f32 v211, v211, v215, -1.0
	s_waitcnt lgkmcnt(6)
	v_mfma_f32_32x32x16_bf16 v[132:147], v[148:151], v[28:31], v[132:147]
	ds_read_b64_tr_b16 v[164:165], v218 offset:32768
	ds_read_b64_tr_b16 v[166:167], v218 offset:33280
	s_add_u32 m0, s30, 147456
	s_nop 0
	buffer_load_dwordx4 v3, s[12:15], s39 offen lds
	s_add_u32 s39, s39, 458752
	v_mfma_f32_4x4x4_16b_bf16 v[180:183], v[216:217], v[148:149], v[180:183]
	v_rcp_f32 v208, v208
	v_rcp_f32 v209, v209
	v_rcp_f32 v210, v210
	s_waitcnt lgkmcnt(6)
	v_mfma_f32_32x32x16_bf16 v[132:147], v[152:155], v[32:35], v[132:147]
	ds_read_b64_tr_b16 v[168:169], v219 offset:32768
	ds_read_b64_tr_b16 v[170:171], v219 offset:33280
	v_mfma_f32_4x4x4_16b_bf16 v[180:183], v[216:217], v[150:151], v[180:183]
	v_rcp_f32 v211, v211
	v_fmac_f32 v120, v120, v208
	v_fmac_f32 v121, v121, v209
	v_fmac_f32 v122, v122, v210
	v_fmac_f32 v123, v123, v211
	v_cvt_pk_bf16_f32 v194, v120, v121
	s_waitcnt lgkmcnt(6)
	v_mfma_f32_32x32x16_bf16 v[132:147], v[156:159], v[84:87], v[132:147]
	ds_read_b64_tr_b16 v[172:173], v220 offset:32768
	ds_read_b64_tr_b16 v[174:175], v220 offset:33280
	s_add_u32 m0, s30, 114688
	s_nop 0
	buffer_load_dwordx4 v3, s[12:15], s39 offen lds
	s_add_u32 s39, s39, 458752
	v_cvt_pk_bf16_f32 v195, v122, v123
	buffer_store_dwordx4 v[192:195], v2, s[16:19], s40 offen offset:0 sc1
	v_mul_f32 v124, v124, v222
	v_mul_f32 v125, v125, v222
	v_mul_f32 v126, v126, v222
	v_mul_f32 v127, v127, v222
	s_waitcnt lgkmcnt(6)
	v_mfma_f32_32x32x16_bf16 v[132:147], v[160:163], v[88:91], v[132:147]
	ds_read_b64_tr_b16 v[176:177], v221 offset:32768
	ds_read_b64_tr_b16 v[178:179], v221 offset:33280
	s_and_b32 s32, s2, 3
	s_lshl_b32 s32, s32, 5
	s_lshr_b32 s33, s2, 3
	s_add_u32 s32, s32, s33
	s_lshl_b32 s32, s32, 3
	s_add_u32 s32, s32, s24
	s_mul_i32 s33, s32, 13
	v_min_u32 v225, 12, v0
	v_add_u32 v225, s33, v225
	v_lshlrev_b32 v225, 7, v225
	buffer_load_dword v254, v225, s[68:71], 0 offen
	s_mul_i32 s33, s32, 4
	v_min_u32 v226, 3, v0
	v_add_u32 v226, s33, v226
	v_lshlrev_b32 v226, 7, v226
	buffer_load_dword v254, v226, s[72:75], 0 offen
	s_waitcnt lgkmcnt(6)
	v_mfma_f32_32x32x16_bf16 v[132:147], v[164:167], v[36:39], v[132:147]
	ds_read_b64_tr_b16 v[148:149], v218 offset:40960
	ds_read_b64_tr_b16 v[150:151], v218 offset:41472
	v_mfma_f32_4x4x4_16b_bf16 v[180:183], v[216:217], v[164:165], v[180:183]
	s_nop 8
	v_readfirstlane_b32 s100, v229
	s_mov_b32 s53, 0
	s_nop 2
parallel_sum__linear_kernel_hedgehog__dense_activation_mish__prompt_kernel_tr17:
	s_cmp_lg_u32 s100, 0
	s_cbranch_scc1 parallel_sum__linear_kernel_hedgehog__dense_activation_mish__prompt_kernel_tk18
	v_mov_b32 v229, 0
	global_load_dword v229, v229, s[96:97] sc1
	s_waitcnt vmcnt(0)
	v_readfirstlane_b32 s100, v229
	s_add_u32 s53, s53, 1
	s_cmp_lt_u32 s53, 0x1000
	s_cbranch_scc1 parallel_sum__linear_kernel_hedgehog__dense_activation_mish__prompt_kernel_tr17
parallel_sum__linear_kernel_hedgehog__dense_activation_mish__prompt_kernel_tk18:
	s_and_b32 s100, s100, -8
	s_add_u32 s100, s100, 1
	s_nop 1
	v_exp_f32 v208, v124
	v_exp_f32 v209, v125
	v_exp_f32 v210, v126
	s_and_b32 s83, s2, 7
	s_lshr_b32 s84, s2, 3
	s_lshl_b32 s85, s83, 5
	s_sub_u32 s85, s85, 128
	s_add_u32 s85, s85, s84
	s_waitcnt lgkmcnt(6)
	v_mfma_f32_32x32x16_bf16 v[132:147], v[168:171], v[40:43], v[132:147]
	ds_read_b64_tr_b16 v[152:153], v219 offset:40960
	ds_read_b64_tr_b16 v[154:155], v219 offset:41472
	v_mfma_f32_4x4x4_16b_bf16 v[180:183], v[216:217], v[166:167], v[180:183]
	v_exp_f32 v211, v127
	v_fma_f32 v212, v208, -0.5, -1.0
	v_fma_f32 v213, v209, -0.5, -1.0
	v_fma_f32 v214, v210, -0.5, -1.0
	v_fma_f32 v215, v211, -0.5, -1.0
	v_fma_f32 v208, v208, v212, -1.0
	v_fma_f32 v209, v209, v213, -1.0
	s_mul_i32 s4, s85, 9363
	s_lshr_b32 s4, s4, 16
	s_mul_i32 s86, s4, 7
	s_sub_u32 s5, s85, s86
	s_waitcnt lgkmcnt(6)
	v_mfma_f32_32x32x16_bf16 v[132:147], v[172:175], v[92:95], v[132:147]
	ds_read_b64_tr_b16 v[156:157], v220 offset:40960
	ds_read_b64_tr_b16 v[158:159], v220 offset:41472
	v_fma_f32 v210, v210, v214, -1.0
	v_fma_f32 v211, v211, v215, -1.0
	v_rcp_f32 v208, v208
	v_rcp_f32 v209, v209
	v_rcp_f32 v210, v210
	s_lshl_b32 s5, s5, 7
	s_lshr_b32 s54, s24, 1
	s_and_b32 s55, s24, 1
	s_lshl_b32 s83, s4, 1
	s_add_u32 s83, s83, s55
	s_lshl_b32 s7, s83, 12
	s_waitcnt lgkmcnt(6)
	v_mfma_f32_32x32x16_bf16 v[132:147], v[176:179], v[96:99], v[132:147]
	ds_read_b64_tr_b16 v[160:161], v221 offset:40960
	ds_read_b64_tr_b16 v[162:163], v221 offset:41472
	v_rcp_f32 v211, v211
	v_fmac_f32 v124, v124, v208
	v_fmac_f32 v125, v125, v209
	v_fmac_f32 v126, v126, v210
	v_fmac_f32 v127, v127, v211
	v_cvt_pk_bf16_f32 v196, v124, v125
	v_cvt_pk_bf16_f32 v197, v126, v127
	v_mul_f32 v128, v128, v222
	v_mul_f32 v129, v129, v222
	s_lshl_b32 s84, s54, 9
	s_add_u32 s7, s7, s84
	s_mul_i32 s83, s83, 144
	s_add_u32 s83, s83, 2048
	s_mul_i32 s84, s54, 28
	s_waitcnt lgkmcnt(6)
	v_mfma_f32_32x32x16_bf16 v[132:147], v[148:151], v[44:47], v[132:147]
	ds_read_b64_tr_b16 v[164:165], v218 offset:49152
	ds_read_b64_tr_b16 v[166:167], v218 offset:49664
	v_mfma_f32_4x4x4_16b_bf16 v[180:183], v[216:217], v[148:149], v[180:183]
	v_mul_f32 v130, v130, v222
	v_mul_f32 v131, v131, v222
	v_exp_f32 v208, v128
	v_exp_f32 v209, v129
	v_exp_f32 v210, v130
	s_add_u32 s88, s83, s84
	s_lshl_b32 s88, s88, 10
	s_lshl_b32 s84, s54, 3
	s_add_u32 s89, s83, s84
	s_waitcnt lgkmcnt(6)
	v_mfma_f32_32x32x16_bf16 v[132:147], v[152:155], v[48:51], v[132:147]
	ds_read_b64_tr_b16 v[168:169], v219 offset:49152
	ds_read_b64_tr_b16 v[170:171], v219 offset:49664
	v_mfma_f32_4x4x4_16b_bf16 v[180:183], v[216:217], v[150:151], v[180:183]
	s_waitcnt lgkmcnt(3)
	s_nop 0
	v_mfma_f32_4x4x4_16b_bf16 v[180:183], v[216:217], v[164:165], v[180:183]
	v_add_u32 v218, 0xe000, v218
	v_exp_f32 v211, v131
	v_fma_f32 v212, v208, -0.5, -1.0
	v_fma_f32 v213, v209, -0.5, -1.0
	s_add_u32 s89, s89, 112
	s_lshl_b32 s89, s89, 10
	s_mul_i32 s83, s4, 57344
	s_add_u32 s94, s83, s5
	v_lshrrev_b32 v225, 3, v0
	v_mfma_f32_32x32x16_bf16 v[132:147], v[156:159], v[100:103], v[132:147]
	ds_read_b64_tr_b16 v[172:173], v220 offset:49152
	ds_read_b64_tr_b16 v[174:175], v220 offset:49664
	s_waitcnt lgkmcnt(4)
	v_mfma_f32_4x4x4_16b_bf16 v[180:183], v[216:217], v[166:167], v[180:183]
	v_add_u32 v219, 0xe000, v219
	v_fma_f32 v214, v210, -0.5, -1.0
	v_fma_f32 v215, v211, -0.5, -1.0
	v_fma_f32 v208, v208, v212, -1.0
	v_fma_f32 v209, v209, v213, -1.0
	v_fma_f32 v210, v210, v214, -1.0
	v_fma_f32 v211, v211, v215, -1.0
	v_and_b32 v226, 7, v0
	v_lshrrev_b32 v227, 2, v0
	v_and_b32 v227, 4, v227
	v_xor_b32 v226, v226, v227
	v_lshlrev_b32 v226, 4, v226
	v_mfma_f32_32x32x16_bf16 v[132:147], v[160:163], v[104:107], v[132:147]
	ds_read_b64_tr_b16 v[176:177], v221 offset:49152
	ds_read_b64_tr_b16 v[178:179], v221 offset:49664
	v_add_u32 v220, 0xe000, v220
	ds_write_b32 v223, v180 offset:2048
	v_rcp_f32 v208, v208
	v_rcp_f32 v209, v209
	v_rcp_f32 v210, v210
	v_rcp_f32 v211, v211
	s_lshl_b32 s83, s24, 3
	v_add_u32 v227, s83, v225
	s_movk_i32 s84, 896
	v_mad_u32_u24 v1, v227, s84, v226
	s_waitcnt vmcnt(7)
	s_waitcnt lgkmcnt(0)
	s_barrier
	v_mfma_f32_32x32x16_bf16 v[132:147], v[164:167], v[52:55], v[132:147]
	ds_read_b64_tr_b16 v[148:149], v218 offset:0
	ds_read_b64_tr_b16 v[150:151], v218 offset:512
	v_add_u32 v221, 0xe000, v221
	v_fmac_f32 v128, v128, v208
	v_fmac_f32 v129, v129, v209
	v_fmac_f32 v130, v130, v210
	v_fmac_f32 v131, v131, v211
	v_cvt_pk_bf16_f32 v198, v128, v129
	v_cvt_pk_bf16_f32 v199, v130, v131
	buffer_store_dwordx4 v[196:199], v2, s[16:19], s40 offen offset:1024 sc1
	s_add_u32 s40, s40, 4096
	v_mfma_f32_32x32x16_bf16 v[132:147], v[168:171], v[56:59], v[132:147]
	ds_read_b64_tr_b16 v[152:153], v219 offset:0
	ds_read_b64_tr_b16 v[154:155], v219 offset:512
	s_add_u32 m0, s30, 0
	s_nop 0
	buffer_load_dwordx4 v1, s[68:71], s5 offen lds
	ds_read_b128 v[208:211], v224 offset:2048
	s_waitcnt lgkmcnt(0)
	v_add_f32 v208, v208, v209
	v_add_f32 v210, v210, v211
	v_mfma_f32_32x32x16_bf16 v[132:147], v[172:175], v[108:111], v[132:147]
	ds_read_b64_tr_b16 v[156:157], v220 offset:0
	ds_read_b64_tr_b16 v[158:159], v220 offset:512
	s_add_u32 m0, s30, 8192
	s_add_u32 s81, s5, 401408
	buffer_load_dwordx4 v1, s[68:71], s81 offen lds
	v_add_f32 v208, v208, v210
	v_cvt_pk_bf16_f32 v184, -v208, -v208
	v_lshlrev_b32 v211, 16, v234
	v_and_b32 v210, 0xffff0000, v184
	v_mfma_f32_32x32x16_bf16 v[132:147], v[176:179], v[112:115], v[132:147]
	ds_read_b64_tr_b16 v[160:161], v221 offset:0
	ds_read_b64_tr_b16 v[162:163], v221 offset:512
	s_add_u32 m0, s30, 16384
	s_add_u32 s81, s5, 802816
	buffer_load_dwordx4 v1, s[68:71], s81 offen lds
	v_add_f32 v210, v208, v210
	v_cvt_pk_bf16_f32 v185, -v210, v211
	v_mov_b32 v186, v234
	v_mfma_f32_32x32x16_bf16 v[116:131], v[148:151], v[4:7], 0
	ds_read_b64_tr_b16 v[164:165], v218 offset:8192
	ds_read_b64_tr_b16 v[166:167], v218 offset:8704
	s_add_u32 m0, s30, 24576
	s_add_u32 s81, s5, 1204224
	buffer_load_dwordx4 v1, s[68:71], s81 offen lds
	v_mfma_f32_4x4x4_16b_bf16 v[180:183], v[216:217], v[148:149], 0
	v_mfma_f32_32x32x16_bf16 v[132:147], v[184:187], v[188:191], v[132:147]
	v_mfma_f32_32x32x16_bf16 v[116:131], v[152:155], v[8:11], v[116:131]
	ds_read_b64_tr_b16 v[168:169], v219 offset:8192
	ds_read_b64_tr_b16 v[170:171], v219 offset:8704
	v_mfma_f32_4x4x4_16b_bf16 v[180:183], v[216:217], v[150:151], v[180:183]
	s_waitcnt lgkmcnt(6)
	v_mfma_f32_32x32x16_bf16 v[116:131], v[156:159], v[60:63], v[116:131]
	ds_read_b64_tr_b16 v[172:173], v220 offset:8192
	ds_read_b64_tr_b16 v[174:175], v220 offset:8704
	s_nop 3
	v_mul_f32 v132, v132, v222
	v_mul_f32 v133, v133, v222
	v_mul_f32 v134, v134, v222
	v_mul_f32 v135, v135, v222
	v_exp_f32 v208, v132
	v_exp_f32 v209, v133
	s_waitcnt lgkmcnt(6)
	v_mfma_f32_32x32x16_bf16 v[116:131], v[160:163], v[64:67], v[116:131]
	ds_read_b64_tr_b16 v[176:177], v221 offset:8192
	ds_read_b64_tr_b16 v[178:179], v221 offset:8704
	v_exp_f32 v210, v134
	v_exp_f32 v211, v135
	v_fma_f32 v212, v208, -0.5, -1.0
	v_fma_f32 v213, v209, -0.5, -1.0
	v_fma_f32 v214, v210, -0.5, -1.0
	s_barrier
	s_waitcnt lgkmcnt(6)
	v_mfma_f32_32x32x16_bf16 v[116:131], v[164:167], v[12:15], v[116:131]
	ds_read_b64_tr_b16 v[148:149], v218 offset:16384
	ds_read_b64_tr_b16 v[150:151], v218 offset:16896
	s_add_u32 m0, s30, 32768
	s_add_u32 s81, s5, 229376
	buffer_load_dwordx4 v1, s[68:71], s81 offen lds
	v_mfma_f32_4x4x4_16b_bf16 v[180:183], v[216:217], v[164:165], v[180:183]
	v_fma_f32 v215, v211, -0.5, -1.0
	v_fma_f32 v208, v208, v212, -1.0
	v_fma_f32 v209, v209, v213, -1.0
	v_fma_f32 v210, v210, v214, -1.0
	v_fma_f32 v211, v211, v215, -1.0
	s_waitcnt lgkmcnt(6)
	v_mfma_f32_32x32x16_bf16 v[116:131], v[168:171], v[16:19], v[116:131]
	ds_read_b64_tr_b16 v[152:153], v219 offset:16384
	ds_read_b64_tr_b16 v[154:155], v219 offset:16896
	s_add_u32 m0, s30, 40960
	s_add_u32 s81, s5, 630784
	buffer_load_dwordx4 v1, s[68:71], s81 offen lds
	v_mfma_f32_4x4x4_16b_bf16 v[180:183], v[216:217], v[166:167], v[180:183]
	v_rcp_f32 v208, v208
	v_rcp_f32 v209, v209
	v_rcp_f32 v210, v210
	s_waitcnt lgkmcnt(6)
	v_mfma_f32_32x32x16_bf16 v[116:131], v[172:175], v[68:71], v[116:131]
	ds_read_b64_tr_b16 v[156:157], v220 offset:16384
	ds_read_b64_tr_b16 v[158:159], v220 offset:16896
	s_waitcnt vmcnt(6)
	s_add_u32 s53, s100, 0
	v_mov_b32 v228, s53
	s_mov_b32 exec_hi, 0
	buffer_store_dword v228, v232, s[16:19], s101 offen sc1
	s_mov_b64 exec, -1
	s_add_u32 m0, s30, 49152
	s_add_u32 s81, s5, 1032192
	buffer_load_dwordx4 v1, s[68:71], s81 offen lds
	v_rcp_f32 v211, v211
	s_waitcnt lgkmcnt(6)
	v_mfma_f32_32x32x16_bf16 v[116:131], v[176:179], v[72:75], v[116:131]
	ds_read_b64_tr_b16 v[160:161], v221 offset:16384
	ds_read_b64_tr_b16 v[162:163], v221 offset:16896
	s_add_u32 m0, s30, 57344
	s_add_u32 s81, s5, 1433600
	buffer_load_dwordx4 v1, s[68:71], s81 offen lds
	v_fmac_f32 v132, v132, v208
	v_fmac_f32 v133, v133, v209
	v_fmac_f32 v134, v134, v210
	v_fmac_f32 v135, v135, v211
	v_cvt_pk_bf16_f32 v192, v132, v133
	v_cvt_pk_bf16_f32 v193, v134, v135
	v_mul_f32 v136, v136, v222
	s_waitcnt lgkmcnt(6)
	v_mfma_f32_32x32x16_bf16 v[116:131], v[148:151], v[20:23], v[116:131]
	ds_read_b64_tr_b16 v[164:165], v218 offset:24576
	ds_read_b64_tr_b16 v[166:167], v218 offset:25088
	v_mfma_f32_4x4x4_16b_bf16 v[180:183], v[216:217], v[148:149], v[180:183]
	v_mul_f32 v137, v137, v222
	v_mul_f32 v138, v138, v222
	v_mul_f32 v139, v139, v222
	v_exp_f32 v208, v136
	s_waitcnt lgkmcnt(6)
	v_mfma_f32_32x32x16_bf16 v[116:131], v[152:155], v[24:27], v[116:131]
	ds_read_b64_tr_b16 v[168:169], v219 offset:24576
	ds_read_b64_tr_b16 v[170:171], v219 offset:25088
	v_mfma_f32_4x4x4_16b_bf16 v[180:183], v[216:217], v[150:151], v[180:183]
	v_exp_f32 v209, v137
	v_exp_f32 v210, v138
	v_exp_f32 v211, v139
	s_waitcnt lgkmcnt(6)
	v_mfma_f32_32x32x16_bf16 v[116:131], v[156:159], v[76:79], v[116:131]
	ds_read_b64_tr_b16 v[172:173], v220 offset:24576
	ds_read_b64_tr_b16 v[174:175], v220 offset:25088
	v_fma_f32 v212, v208, -0.5, -1.0
	v_fma_f32 v213, v209, -0.5, -1.0
	v_fma_f32 v214, v210, -0.5, -1.0
	v_fma_f32 v215, v211, -0.5, -1.0
	v_fma_f32 v208, v208, v212, -1.0
	v_fma_f32 v209, v209, v213, -1.0
	v_fma_f32 v210, v210, v214, -1.0
	s_waitcnt lgkmcnt(6)
	v_mfma_f32_32x32x16_bf16 v[116:131], v[160:163], v[80:83], v[116:131]
	ds_read_b64_tr_b16 v[176:177], v221 offset:24576
	ds_read_b64_tr_b16 v[178:179], v221 offset:25088
	v_fma_f32 v211, v211, v215, -1.0
	v_rcp_f32 v208, v208
	v_rcp_f32 v209, v209
	v_rcp_f32 v210, v210
	s_waitcnt lgkmcnt(6)
	v_mfma_f32_32x32x16_bf16 v[116:131], v[164:167], v[28:31], v[116:131]
	ds_read_b64_tr_b16 v[148:149], v218 offset:32768
	ds_read_b64_tr_b16 v[150:151], v218 offset:33280
	v_mfma_f32_4x4x4_16b_bf16 v[180:183], v[216:217], v[164:165], v[180:183]
	v_rcp_f32 v211, v211
	v_fmac_f32 v136, v136, v208
	v_fmac_f32 v137, v137, v209
	v_fmac_f32 v138, v138, v210
	v_fmac_f32 v139, v139, v211
	s_waitcnt lgkmcnt(6)
	v_mfma_f32_32x32x16_bf16 v[116:131], v[168:171], v[32:35], v[116:131]
	ds_read_b64_tr_b16 v[152:153], v219 offset:32768
	ds_read_b64_tr_b16 v[154:155], v219 offset:33280
	v_mfma_f32_4x4x4_16b_bf16 v[180:183], v[216:217], v[166:167], v[180:183]
	v_cvt_pk_bf16_f32 v194, v136, v137
	v_cvt_pk_bf16_f32 v195, v138, v139
	buffer_store_dwordx4 v[192:195], v2, s[16:19], s40 offen offset:0 sc1
	v_mul_f32 v140, v140, v222
	v_mul_f32 v141, v141, v222
	s_waitcnt lgkmcnt(6)
	v_mfma_f32_32x32x16_bf16 v[116:131], v[172:175], v[84:87], v[116:131]
	ds_read_b64_tr_b16 v[156:157], v220 offset:32768
	ds_read_b64_tr_b16 v[158:159], v220 offset:33280
	v_mul_f32 v142, v142, v222
	v_mul_f32 v143, v143, v222
	v_exp_f32 v208, v140
	v_exp_f32 v209, v141
	v_exp_f32 v210, v142
	s_waitcnt lgkmcnt(6)
	v_mfma_f32_32x32x16_bf16 v[116:131], v[176:179], v[88:91], v[116:131]
	ds_read_b64_tr_b16 v[160:161], v221 offset:32768
	ds_read_b64_tr_b16 v[162:163], v221 offset:33280
	v_exp_f32 v211, v143
	v_fma_f32 v212, v208, -0.5, -1.0
	v_fma_f32 v213, v209, -0.5, -1.0
	v_fma_f32 v214, v210, -0.5, -1.0
	v_fma_f32 v215, v211, -0.5, -1.0
	v_fma_f32 v208, v208, v212, -1.0
	s_waitcnt lgkmcnt(6)
	v_mfma_f32_32x32x16_bf16 v[116:131], v[148:151], v[36:39], v[116:131]
	ds_read_b64_tr_b16 v[164:165], v218 offset:40960
	ds_read_b64_tr_b16 v[166:167], v218 offset:41472
	v_mfma_f32_4x4x4_16b_bf16 v[180:183], v[216:217], v[148:149], v[180:183]
	v_fma_f32 v209, v209, v213, -1.0
	v_fma_f32 v210, v210, v214, -1.0
	v_fma_f32 v211, v211, v215, -1.0
	v_rcp_f32 v208, v208
	s_waitcnt lgkmcnt(6)
	v_mfma_f32_32x32x16_bf16 v[116:131], v[152:155], v[40:43], v[116:131]
	ds_read_b64_tr_b16 v[168:169], v219 offset:40960
	ds_read_b64_tr_b16 v[170:171], v219 offset:41472
	v_mfma_f32_4x4x4_16b_bf16 v[180:183], v[216:217], v[150:151], v[180:183]
	v_rcp_f32 v209, v209
	v_rcp_f32 v210, v210
	v_rcp_f32 v211, v211
	s_waitcnt lgkmcnt(6)
	v_mfma_f32_32x32x16_bf16 v[116:131], v[156:159], v[92:95], v[116:131]
	ds_read_b64_tr_b16 v[172:173], v220 offset:40960
	ds_read_b64_tr_b16 v[174:175], v220 offset:41472
	s_mov_b64 exec, 0xf
	buffer_load_dword v230, v231, s[16:19], s7 offen offset:2048 sc1
	s_mov_b64 exec, -1
	v_fmac_f32 v140, v140, v208
	v_fmac_f32 v141, v141, v209
	v_fmac_f32 v142, v142, v210
	v_fmac_f32 v143, v143, v211
	v_cvt_pk_bf16_f32 v196, v140, v141
	v_cvt_pk_bf16_f32 v197, v142, v143
	v_mul_f32 v144, v144, v222
	s_waitcnt lgkmcnt(6)
	v_mfma_f32_32x32x16_bf16 v[116:131], v[160:163], v[96:99], v[116:131]
	ds_read_b64_tr_b16 v[176:177], v221 offset:40960
	ds_read_b64_tr_b16 v[178:179], v221 offset:41472
	v_mul_f32 v145, v145, v222
	v_mul_f32 v146, v146, v222
	v_mul_f32 v147, v147, v222
	v_exp_f32 v208, v144
	v_exp_f32 v209, v145
	s_barrier
	s_waitcnt lgkmcnt(6)
	v_mfma_f32_32x32x16_bf16 v[116:131], v[164:167], v[44:47], v[116:131]
	ds_read_b64_tr_b16 v[148:149], v218 offset:49152
	ds_read_b64_tr_b16 v[150:151], v218 offset:49664
	s_add_u32 m0, s30, 65536
	s_add_u32 s81, s5, 57344
	buffer_load_dwordx4 v1, s[68:71], s81 offen lds
	v_mfma_f32_4x4x4_16b_bf16 v[180:183], v[216:217], v[164:165], v[180:183]
	v_exp_f32 v210, v146
	v_exp_f32 v211, v147
	v_fma_f32 v212, v208, -0.5, -1.0
	v_fma_f32 v213, v209, -0.5, -1.0
	s_waitcnt lgkmcnt(6)
	v_mfma_f32_32x32x16_bf16 v[116:131], v[168:171], v[48:51], v[116:131]
	ds_read_b64_tr_b16 v[152:153], v219 offset:49152
	ds_read_b64_tr_b16 v[154:155], v219 offset:49664
	s_add_u32 m0, s30, 73728
	s_add_u32 s81, s5, 458752
	buffer_load_dwordx4 v1, s[68:71], s81 offen lds
	v_mfma_f32_4x4x4_16b_bf16 v[180:183], v[216:217], v[166:167], v[180:183]
	s_waitcnt lgkmcnt(3)
	s_nop 0
	v_mfma_f32_4x4x4_16b_bf16 v[180:183], v[216:217], v[148:149], v[180:183]
	v_fma_f32 v214, v210, -0.5, -1.0
	v_fma_f32 v215, v211, -0.5, -1.0
	v_fma_f32 v208, v208, v212, -1.0
	v_mfma_f32_32x32x16_bf16 v[116:131], v[172:175], v[100:103], v[116:131]
	ds_read_b64_tr_b16 v[156:157], v220 offset:49152
	ds_read_b64_tr_b16 v[158:159], v220 offset:49664
	s_add_u32 m0, s30, 81920
	s_add_u32 s81, s5, 860160
	buffer_load_dwordx4 v1, s[68:71], s81 offen lds
	s_waitcnt lgkmcnt(4)
	v_mfma_f32_4x4x4_16b_bf16 v[180:183], v[216:217], v[150:151], v[180:183]
	v_fma_f32 v209, v209, v213, -1.0
	v_fma_f32 v210, v210, v214, -1.0
	v_fma_f32 v211, v211, v215, -1.0
	v_rcp_f32 v208, v208
	v_mfma_f32_32x32x16_bf16 v[116:131], v[176:179], v[104:107], v[116:131]
	ds_read_b64_tr_b16 v[160:161], v221 offset:49152
	ds_read_b64_tr_b16 v[162:163], v221 offset:49664
	s_add_u32 m0, s30, 90112
	s_add_u32 s81, s5, 1261568
	buffer_load_dwordx4 v1, s[68:71], s81 offen lds
	ds_write_b32 v223, v180 offset:0
	v_rcp_f32 v209, v209
	v_rcp_f32 v210, v210
	v_rcp_f32 v211, v211
	v_fmac_f32 v144, v144, v208
	s_waitcnt lgkmcnt(0)
	s_barrier
	v_mfma_f32_32x32x16_bf16 v[116:131], v[148:151], v[52:55], v[116:131]
	ds_read_b64_tr_b16 v[164:165], v237 offset:16384
	ds_read_b64_tr_b16 v[166:167], v237 offset:16896
	v_fmac_f32 v145, v145, v209
	v_fmac_f32 v146, v146, v210
	v_fmac_f32 v147, v147, v211
	v_cvt_pk_bf16_f32 v198, v144, v145
	v_cvt_pk_bf16_f32 v199, v146, v147
	buffer_store_dwordx4 v[196:199], v2, s[16:19], s40 offen offset:1024 sc1
	s_add_u32 s40, s40, 4096
	v_mfma_f32_32x32x16_bf16 v[116:131], v[152:155], v[56:59], v[116:131]
	ds_read_b64_tr_b16 v[168:169], v238 offset:16384
	ds_read_b64_tr_b16 v[170:171], v238 offset:16896
	s_waitcnt vmcnt(5)
	s_nop 8
	s_mov_b32 s53, 0
	s_add_u32 s35, s100, 0
parallel_sum__linear_kernel_hedgehog__dense_activation_mish__prompt_kernel_pl19:
	v_subrev_u32 v228, s35, v230
	v_cmp_gt_u32 vcc, 7, v228
	s_nop 3
	s_and_b32 s34, vcc_lo, 15
	s_cmp_eq_u32 s34, 15
	s_cbranch_scc1 parallel_sum__linear_kernel_hedgehog__dense_activation_mish__prompt_kernel_pk20
	s_mov_b64 exec, 0xf
	buffer_load_dword v230, v231, s[16:19], s7 offen offset:2048 sc1
	s_mov_b64 exec, -1
	s_add_u32 s53, s53, 1
	s_waitcnt vmcnt(0)
	s_cmp_lt_u32 s53, 0x1000
	s_cbranch_scc1 parallel_sum__linear_kernel_hedgehog__dense_activation_mish__prompt_kernel_pl19
parallel_sum__linear_kernel_hedgehog__dense_activation_mish__prompt_kernel_pk20:
	s_nop 1
	buffer_load_dwordx4 v[60:63], v2, s[16:19], s88 offen offset:0
	ds_read_b128 v[208:211], v224 offset:0
	s_waitcnt lgkmcnt(0)
	v_add_f32 v208, v208, v209
	v_add_f32 v210, v210, v211
	v_mfma_f32_32x32x16_bf16 v[116:131], v[156:159], v[108:111], v[116:131]
	ds_read_b64_tr_b16 v[172:173], v237 offset:20480
	ds_read_b64_tr_b16 v[174:175], v237 offset:20992
	buffer_load_dwordx4 v[64:67], v2, s[16:19], s88 offen offset:1024
	v_add_f32 v208, v208, v210
	v_cvt_pk_bf16_f32 v184, -v208, -v208
	v_lshlrev_b32 v211, 16, v235
	v_and_b32 v210, 0xffff0000, v184
	v_mfma_f32_32x32x16_bf16 v[116:131], v[160:163], v[112:115], v[116:131]
	ds_read_b64_tr_b16 v[176:177], v238 offset:20480
	ds_read_b64_tr_b16 v[178:179], v238 offset:20992
	buffer_load_dwordx4 v[68:71], v2, s[16:19], s88 offen offset:2048
	v_add_f32 v210, v208, v210
	v_cvt_pk_bf16_f32 v185, -v210, v211
	v_mov_b32 v186, v235
	v_mfma_f32_32x32x16_bf16 v[132:147], v[164:167], v[4:7], 0
	ds_read_b64_tr_b16 v[148:149], v237 offset:24576
	ds_read_b64_tr_b16 v[150:151], v237 offset:25088
	buffer_load_dwordx4 v[72:75], v2, s[16:19], s88 offen offset:3072
	v_mfma_f32_4x4x4_16b_bf16 v[180:183], v[216:217], v[164:165], 0
	s_nop 1
	v_mfma_f32_4x4x4_16b_bf16 v[180:183], v[216:217], v[166:167], v[180:183]
	v_mfma_f32_32x32x16_bf16 v[116:131], v[184:187], v[188:191], v[116:131]
	v_lshrrev_b32 v218, 5, v0
	v_lshlrev_b32 v218, 9, v218
	v_bfe_u32 v219, v0, 2, 2
	v_mfma_f32_32x32x16_bf16 v[132:147], v[168:171], v[8:11], v[132:147]
	ds_read_b64_tr_b16 v[152:153], v238 offset:24576
	ds_read_b64_tr_b16 v[154:155], v238 offset:25088
	s_add_u32 s80, s88, 16384
	buffer_load_dwordx4 v[76:79], v2, s[16:19], s80 offen offset:0
	v_mfma_f32_4x4x4_16b_bf16 v[180:183], v[216:217], v[168:169], v[180:183]
	s_nop 1
	v_mfma_f32_4x4x4_16b_bf16 v[180:183], v[216:217], v[170:171], v[180:183]
	v_lshl_add_u32 v218, v219, 7, v218
	v_bfe_u32 v219, v0, 4, 1
	v_lshl_add_u32 v218, v219, 5, v218
	v_and_b32 v219, 3, v0
	v_lshl_add_u32 v218, v219, 3, v218
	v_bfe_u32 v219, v0, 3, 1
	v_lshl_add_u32 v218, v219, 6, v218
	s_lshl_b32 s83, s54, 13
	v_add_u32 v218, s83, v218
	s_waitcnt lgkmcnt(6)
	v_mfma_f32_32x32x16_bf16 v[132:147], v[172:175], v[12:15], v[132:147]
	ds_read_b64_tr_b16 v[156:157], v237 offset:28672
	ds_read_b64_tr_b16 v[158:159], v237 offset:29184
	buffer_load_dwordx4 v[80:83], v2, s[16:19], s80 offen offset:1024
	v_mfma_f32_4x4x4_16b_bf16 v[180:183], v[216:217], v[172:173], v[180:183]
	s_nop 1
	v_mfma_f32_4x4x4_16b_bf16 v[180:183], v[216:217], v[174:175], v[180:183]
	v_mul_f32 v116, v116, v222
	v_mul_f32 v117, v117, v222
	v_mul_f32 v118, v118, v222
	v_mul_f32 v119, v119, v222
	v_exp_f32 v208, v116
	v_exp_f32 v209, v117
	v_exp_f32 v210, v118
	v_exp_f32 v211, v119
	s_waitcnt lgkmcnt(6)
	v_mfma_f32_32x32x16_bf16 v[132:147], v[176:179], v[16:19], v[132:147]
	ds_read_b64_tr_b16 v[160:161], v238 offset:28672
	ds_read_b64_tr_b16 v[162:163], v238 offset:29184
	buffer_load_dwordx4 v[84:87], v2, s[16:19], s80 offen offset:2048
	v_mfma_f32_4x4x4_16b_bf16 v[180:183], v[216:217], v[176:177], v[180:183]
	s_nop 1
	v_mfma_f32_4x4x4_16b_bf16 v[180:183], v[216:217], v[178:179], v[180:183]
	v_fma_f32 v212, v208, -0.5, -1.0
	v_fma_f32 v213, v209, -0.5, -1.0
	v_fma_f32 v214, v210, -0.5, -1.0
	v_fma_f32 v215, v211, -0.5, -1.0
	v_fma_f32 v208, v208, v212, -1.0
	v_fma_f32 v209, v209, v213, -1.0
	v_fma_f32 v210, v210, v214, -1.0
	v_fma_f32 v211, v211, v215, -1.0
	v_rcp_f32 v208, v208
	v_rcp_f32 v209, v209
	s_waitcnt lgkmcnt(6)
	v_mfma_f32_32x32x16_bf16 v[132:147], v[148:151], v[20:23], v[132:147]
	ds_read_b64_tr_b16 v[164:165], v237 offset:32768
	ds_read_b64_tr_b16 v[166:167], v237 offset:33280
	buffer_load_dwordx4 v[88:91], v2, s[16:19], s80 offen offset:3072
	v_mfma_f32_4x4x4_16b_bf16 v[180:183], v[216:217], v[148:149], v[180:183]
	s_nop 1
	v_mfma_f32_4x4x4_16b_bf16 v[180:183], v[216:217], v[150:151], v[180:183]
	v_rcp_f32 v210, v210
	v_rcp_f32 v211, v211
	v_fmac_f32 v116, v116, v208
	v_fmac_f32 v117, v117, v209
	v_fmac_f32 v118, v118, v210
	v_fmac_f32 v119, v119, v211
	v_cvt_pk_bf16_f32 v192, v116, v117
	v_cvt_pk_bf16_f32 v193, v118, v119
	v_mul_f32 v120, v120, v222
	v_mul_f32 v121, v121, v222
	s_waitcnt lgkmcnt(6)
	v_mfma_f32_32x32x16_bf16 v[132:147], v[152:155], v[24:27], v[132:147]
	ds_read_b64_tr_b16 v[168:169], v238 offset:32768
	ds_read_b64_tr_b16 v[170:171], v238 offset:33280
	v_mfma_f32_4x4x4_16b_bf16 v[180:183], v[216:217], v[152:153], v[180:183]
	s_nop 1
	v_mfma_f32_4x4x4_16b_bf16 v[180:183], v[216:217], v[154:155], v[180:183]
	v_mul_f32 v122, v122, v222
	v_mul_f32 v123, v123, v222
	v_exp_f32 v208, v120
	v_exp_f32 v209, v121
	v_exp_f32 v210, v122
	v_exp_f32 v211, v123
	v_fma_f32 v212, v208, -0.5, -1.0
	v_fma_f32 v213, v209, -0.5, -1.0
	s_waitcnt lgkmcnt(6)
	v_mfma_f32_32x32x16_bf16 v[132:147], v[156:159], v[28:31], v[132:147]
	ds_read_b64_tr_b16 v[172:173], v237 offset:36864
	ds_read_b64_tr_b16 v[174:175], v237 offset:37376
	s_waitcnt vmcnt(8)
	s_add_u32 s53, s100, 1
	v_mov_b32 v228, s53
	s_mov_b32 exec_hi, 0
	buffer_store_dword v228, v232, s[16:19], s101 offen sc1
	s_mov_b64 exec, -1
	v_mfma_f32_4x4x4_16b_bf16 v[180:183], v[216:217], v[156:157], v[180:183]
	s_nop 1
	v_mfma_f32_4x4x4_16b_bf16 v[180:183], v[216:217], v[158:159], v[180:183]
	v_fma_f32 v214, v210, -0.5, -1.0
	v_fma_f32 v215, v211, -0.5, -1.0
	v_fma_f32 v208, v208, v212, -1.0
	v_fma_f32 v209, v209, v213, -1.0
	v_fma_f32 v210, v210, v214, -1.0
	v_fma_f32 v211, v211, v215, -1.0
	v_xor_b32 v219, 64, v218
	s_waitcnt lgkmcnt(6)
	v_mfma_f32_32x32x16_bf16 v[132:147], v[160:163], v[32:35], v[132:147]
	ds_read_b64_tr_b16 v[176:177], v238 offset:36864
	ds_read_b64_tr_b16 v[178:179], v238 offset:37376
	v_mfma_f32_4x4x4_16b_bf16 v[180:183], v[216:217], v[160:161], v[180:183]
	s_nop 1
	v_mfma_f32_4x4x4_16b_bf16 v[180:183], v[216:217], v[162:163], v[180:183]
	v_rcp_f32 v208, v208
	v_rcp_f32 v209, v209
	v_rcp_f32 v210, v210
	v_rcp_f32 v211, v211
	v_fmac_f32 v120, v120, v208
	v_fmac_f32 v121, v121, v209
	v_fmac_f32 v122, v122, v210
	v_fmac_f32 v123, v123, v211
	v_cvt_pk_bf16_f32 v194, v120, v121
	s_waitcnt lgkmcnt(6)
	v_mfma_f32_32x32x16_bf16 v[132:147], v[164:167], v[36:39], v[132:147]
	ds_read_b64_tr_b16 v[148:149], v237 offset:0
	ds_read_b64_tr_b16 v[150:151], v237 offset:512
	v_mfma_f32_4x4x4_16b_bf16 v[180:183], v[216:217], v[164:165], v[180:183]
	s_nop 1
	v_mfma_f32_4x4x4_16b_bf16 v[180:183], v[216:217], v[166:167], v[180:183]
	v_cvt_pk_bf16_f32 v195, v122, v123
	buffer_store_dwordx4 v[192:195], v2, s[16:19], s40 offen offset:0 sc1
	v_mul_f32 v124, v124, v222
	v_mul_f32 v125, v125, v222
	v_mul_f32 v126, v126, v222
	v_mul_f32 v127, v127, v222
	v_exp_f32 v208, v124
	v_exp_f32 v209, v125
	v_exp_f32 v210, v126
	s_waitcnt lgkmcnt(6)
	v_mfma_f32_32x32x16_bf16 v[132:147], v[168:171], v[40:43], v[132:147]
	ds_read_b64_tr_b16 v[152:153], v238 offset:0
	ds_read_b64_tr_b16 v[154:155], v238 offset:512
	v_mfma_f32_4x4x4_16b_bf16 v[180:183], v[216:217], v[168:169], v[180:183]
	s_nop 1
	v_mfma_f32_4x4x4_16b_bf16 v[180:183], v[216:217], v[170:171], v[180:183]
	v_exp_f32 v211, v127
	v_fma_f32 v212, v208, -0.5, -1.0
	v_fma_f32 v213, v209, -0.5, -1.0
	v_fma_f32 v214, v210, -0.5, -1.0
	v_fma_f32 v215, v211, -0.5, -1.0
	v_fma_f32 v208, v208, v212, -1.0
	v_fma_f32 v209, v209, v213, -1.0
	v_fma_f32 v210, v210, v214, -1.0
	v_fma_f32 v211, v211, v215, -1.0
	v_rcp_f32 v208, v208
	s_waitcnt lgkmcnt(0)
	s_barrier
	v_mfma_f32_32x32x16_bf16 v[132:147], v[172:175], v[44:47], v[132:147]
	ds_read_b64_tr_b16 v[156:157], v218 offset:0
	ds_read_b64_tr_b16 v[158:159], v218 offset:1024
	s_mov_b64 exec, 0xf
	buffer_load_dword v230, v231, s[16:19], s7 offen offset:2048 sc1
	s_mov_b64 exec, -1
	s_add_u32 m0, s30, 131072
	s_add_u32 s81, s5, 286720
	buffer_load_dwordx4 v1, s[68:71], s81 offen lds
	v_mfma_f32_4x4x4_16b_bf16 v[180:183], v[216:217], v[172:173], v[180:183]
	s_nop 1
	v_mfma_f32_4x4x4_16b_bf16 v[180:183], v[216:217], v[174:175], v[180:183]
	v_rcp_f32 v209, v209
	v_rcp_f32 v210, v210
	v_rcp_f32 v211, v211
	v_fmac_f32 v124, v124, v208
	v_fmac_f32 v125, v125, v209
	v_fmac_f32 v126, v126, v210
	v_fmac_f32 v127, v127, v211
	v_cvt_pk_bf16_f32 v196, v124, v125
	v_mfma_f32_32x32x16_bf16 v[132:147], v[176:179], v[48:51], v[132:147]
	ds_read_b64_tr_b16 v[160:161], v219 offset:0
	ds_read_b64_tr_b16 v[162:163], v219 offset:1024
	s_add_u32 m0, s30, 139264
	s_add_u32 s81, s5, 688128
	buffer_load_dwordx4 v1, s[68:71], s81 offen lds
	v_mfma_f32_4x4x4_16b_bf16 v[180:183], v[216:217], v[176:177], v[180:183]
	s_nop 1
	v_mfma_f32_4x4x4_16b_bf16 v[180:183], v[216:217], v[178:179], v[180:183]
	v_cvt_pk_bf16_f32 v197, v126, v127
	v_mul_f32 v128, v128, v222
	v_mul_f32 v129, v129, v222
	v_mul_f32 v130, v130, v222
	v_mul_f32 v131, v131, v222
	v_exp_f32 v208, v128
	v_exp_f32 v209, v129
	v_exp_f32 v210, v130
	v_exp_f32 v211, v131
	v_mfma_f32_32x32x16_bf16 v[132:147], v[148:151], v[52:55], v[132:147]
	ds_read_b64_tr_b16 v[164:165], v218 offset:2048
	ds_read_b64_tr_b16 v[166:167], v218 offset:3072
	s_add_u32 m0, s30, 147456
	s_add_u32 s81, s5, 1089536
	buffer_load_dwordx4 v1, s[68:71], s81 offen lds
	v_mfma_f32_4x4x4_16b_bf16 v[180:183], v[216:217], v[148:149], v[180:183]
	s_nop 1
	v_mfma_f32_4x4x4_16b_bf16 v[180:183], v[216:217], v[150:151], v[180:183]
	v_fma_f32 v212, v208, -0.5, -1.0
	v_fma_f32 v213, v209, -0.5, -1.0
	v_fma_f32 v214, v210, -0.5, -1.0
	v_fma_f32 v215, v211, -0.5, -1.0
	v_fma_f32 v208, v208, v212, -1.0
	v_fma_f32 v209, v209, v213, -1.0
	v_fma_f32 v210, v210, v214, -1.0
	v_fma_f32 v211, v211, v215, -1.0
	v_rcp_f32 v208, v208
	v_rcp_f32 v209, v209
	v_mfma_f32_32x32x16_bf16 v[132:147], v[152:155], v[56:59], v[132:147]
	ds_read_b64_tr_b16 v[168:169], v219 offset:2048
	ds_read_b64_tr_b16 v[170:171], v219 offset:3072
	s_add_u32 m0, s30, 155648
	s_add_u32 s81, s5, 1490944
	buffer_load_dwordx4 v1, s[68:71], s81 offen lds
	v_mfma_f32_4x4x4_16b_bf16 v[180:183], v[216:217], v[152:153], v[180:183]
	s_nop 1
	v_mfma_f32_4x4x4_16b_bf16 v[180:183], v[216:217], v[154:155], v[180:183]
	v_rcp_f32 v210, v210
	v_rcp_f32 v211, v211
	v_fmac_f32 v128, v128, v208
	v_fmac_f32 v129, v129, v209
	v_fmac_f32 v130, v130, v210
	v_fmac_f32 v131, v131, v211
	v_cvt_pk_bf16_f32 v198, v128, v129
	v_cvt_pk_bf16_f32 v199, v130, v131
	buffer_store_dwordx4 v[196:199], v2, s[16:19], s40 offen offset:1024 sc1
	s_waitcnt vmcnt(15) lgkmcnt(6)
	v_mfma_f32_32x32x16_bf16 v[4:19], v[156:159], v[60:63], 0
	ds_read_b64_tr_b16 v[172:173], v218 offset:4096
	ds_read_b64_tr_b16 v[174:175], v218 offset:5120
	v_cvt_pk_bf16_f32 v184, -v180, -v180
	v_lshlrev_b32 v209, 16, v236
	v_and_b32 v208, 0xffff0000, v184
	v_add_f32 v208, v180, v208
	v_mul_f32 v209, 0.5, v209
	v_cvt_pk_bf16_f32 v185, -v208, v209
	v_lshrrev_b32 v186, 16, v209
	s_add_u32 m0, s30, 114688
	s_add_u32 s81, s5, 917504
	buffer_load_dwordx4 v1, s[68:71], s81 offen lds
	v_mfma_f32_32x32x16_bf16 v[132:147], v[184:187], v[188:191], v[132:147]
	s_waitcnt lgkmcnt(6)
	v_mfma_f32_32x32x16_bf16 v[20:35], v[160:163], v[60:63], 0
	ds_read_b64_tr_b16 v[176:177], v219 offset:4096
	ds_read_b64_tr_b16 v[178:179], v219 offset:5120
	s_add_u32 m0, s30, 122880
	s_add_u32 s81, s5, 1318912
	buffer_load_dwordx4 v1, s[68:71], s81 offen lds
	s_waitcnt vmcnt(16) lgkmcnt(6)
	v_mfma_f32_32x32x16_bf16 v[4:19], v[164:167], v[64:67], v[4:19]
	ds_read_b64_tr_b16 v[148:149], v218 offset:6144
	ds_read_b64_tr_b16 v[150:151], v218 offset:7168
	s_waitcnt vmcnt(7)
	s_nop 8
	s_mov_b32 s53, 0
	s_add_u32 s35, s100, 1
parallel_sum__linear_kernel_hedgehog__dense_activation_mish__prompt_kernel_pl21:
	v_subrev_u32 v228, s35, v230
	v_cmp_gt_u32 vcc, 6, v228
	s_nop 3
	s_and_b32 s34, vcc_lo, 15
	s_cmp_eq_u32 s34, 15
	s_cbranch_scc1 parallel_sum__linear_kernel_hedgehog__dense_activation_mish__prompt_kernel_pk22
	s_mov_b64 exec, 0xf
	buffer_load_dword v230, v231, s[16:19], s7 offen offset:2048 sc1
	s_mov_b64 exec, -1
	s_add_u32 s53, s53, 1
	s_waitcnt vmcnt(0)
	s_cmp_lt_u32 s53, 0x1000
	s_cbranch_scc1 parallel_sum__linear_kernel_hedgehog__dense_activation_mish__prompt_kernel_pl21
parallel_sum__linear_kernel_hedgehog__dense_activation_mish__prompt_kernel_pk22:
	s_nop 1
	s_add_u32 s82, s88, 4096
	buffer_load_dwordx4 v[92:95], v2, s[16:19], s82 offen offset:0
	s_sub_u32 s42, 0, s26
	s_mov_b32 s43, s42
	v_cndmask_b32 v116, v140, v132, s[42:43]
	v_cndmask_b32 v117, v141, v133, s[42:43]
	v_cndmask_b32 v118, v142, v134, s[42:43]
	v_cndmask_b32 v119, v143, v135, s[42:43]
	v_cndmask_b32 v120, v144, v136, s[42:43]
	v_cndmask_b32 v121, v145, v137, s[42:43]
	v_cndmask_b32 v122, v146, v138, s[42:43]
	v_cndmask_b32 v123, v147, v139, s[42:43]
	v_cndmask_b32 v132, v132, v140, s[42:43]
	v_cndmask_b32 v133, v133, v141, s[42:43]
	v_cndmask_b32 v134, v134, v142, s[42:43]
	s_waitcnt lgkmcnt(6)
	v_mfma_f32_32x32x16_bf16 v[20:35], v[168:171], v[64:67], v[20:35]
	ds_read_b64_tr_b16 v[152:153], v219 offset:6144
	ds_read_b64_tr_b16 v[154:155], v219 offset:7168
	buffer_load_dwordx4 v[96:99], v2, s[16:19], s82 offen offset:1024
	v_cndmask_b32 v135, v135, v143, s[42:43]
	v_cndmask_b32 v136, v136, v144, s[42:43]
	v_cndmask_b32 v137, v137, v145, s[42:43]
	v_cndmask_b32 v138, v138, v146, s[42:43]
	v_cndmask_b32 v139, v139, v147, s[42:43]
	s_lshl_b32 s32, s24, 11
	s_add_u32 s32, s32, 98304
	v_add_u32 v225, s32, v2
	s_xor_b32 s32, s32, 8192
	v_add_u32 v226, s32, v2
	ds_write_b128 v225, v[116:119] offset:0
	ds_write_b128 v225, v[120:123] offset:1024
	s_waitcnt lgkmcnt(0)
	s_barrier
	v_mfma_f32_32x32x16_bf16 v[4:19], v[172:175], v[68:71], v[4:19]
	ds_read_b64_tr_b16 v[156:157], v218 offset:32768
	ds_read_b64_tr_b16 v[158:159], v218 offset:33792
	buffer_load_dwordx4 v[100:103], v2, s[16:19], s82 offen offset:2048
	ds_read_b128 v[116:119], v226 offset:0
	ds_read_b128 v[120:123], v226 offset:1024
	s_waitcnt lgkmcnt(1)
	v_add_f32 v132, v132, v116
	v_add_f32 v133, v133, v117
	v_add_f32 v134, v134, v118
	v_add_f32 v135, v135, v119
	s_waitcnt lgkmcnt(0)
	v_add_f32 v136, v136, v120
	v_mfma_f32_32x32x16_bf16 v[20:35], v[176:179], v[68:71], v[20:35]
	ds_read_b64_tr_b16 v[160:161], v219 offset:32768
	ds_read_b64_tr_b16 v[162:163], v219 offset:33792
	buffer_load_dwordx4 v[104:107], v2, s[16:19], s82 offen offset:3072
	v_add_f32 v137, v137, v121
	v_add_f32 v138, v138, v122
	v_add_f32 v139, v139, v123
	v_mul_f32 v132, v132, v222
	v_mul_f32 v133, v133, v222
	v_mul_f32 v134, v134, v222
	v_mul_f32 v135, v135, v222
	v_mfma_f32_32x32x16_bf16 v[4:19], v[148:151], v[72:75], v[4:19]
	ds_read_b64_tr_b16 v[164:165], v218 offset:34816
	ds_read_b64_tr_b16 v[166:167], v218 offset:35840
	s_waitcnt vmcnt(6)
	s_add_u32 s53, s100, 2
	v_mov_b32 v228, s53
	s_mov_b32 exec_hi, 0
	buffer_store_dword v228, v232, s[16:19], s101 offen sc1
	s_mov_b64 exec, -1
	s_add_u32 s80, s88, 20480
	buffer_load_dwordx4 v[36:39], v2, s[16:19], s80 offen offset:0
	v_exp_f32 v208, v132
	v_exp_f32 v209, v133
	v_exp_f32 v210, v134
	v_exp_f32 v211, v135
	v_mfma_f32_32x32x16_bf16 v[20:35], v[152:155], v[72:75], v[20:35]
	ds_read_b64_tr_b16 v[168:169], v219 offset:34816
	ds_read_b64_tr_b16 v[170:171], v219 offset:35840
	buffer_load_dwordx4 v[40:43], v2, s[16:19], s80 offen offset:1024
	v_fma_f32 v212, v208, -0.5, -1.0
	v_fma_f32 v213, v209, -0.5, -1.0
	v_fma_f32 v214, v210, -0.5, -1.0
	v_fma_f32 v215, v211, -0.5, -1.0
	v_fma_f32 v208, v208, v212, -1.0
	v_fma_f32 v209, v209, v213, -1.0
	v_fma_f32 v210, v210, v214, -1.0
	v_lshrrev_b32 v225, 3, v0
	v_and_b32 v226, 7, v0
	s_lshl_b32 s83, s24, 3
	v_add_u32 v227, s83, v225
	v_mfma_f32_32x32x16_bf16 v[4:19], v[156:159], v[76:79], v[4:19]
	ds_read_b64_tr_b16 v[172:173], v218 offset:36864
	ds_read_b64_tr_b16 v[174:175], v218 offset:37888
	buffer_load_dwordx4 v[44:47], v2, s[16:19], s80 offen offset:2048
	v_fma_f32 v211, v211, v215, -1.0
	v_rcp_f32 v208, v208
	v_rcp_f32 v209, v209
	v_rcp_f32 v210, v210
	s_movk_i32 s84, 896
	v_lshlrev_b32 v220, 4, v226
	v_mad_u32_u24 v220, v227, s84, v220
	buffer_load_dwordx4 v[184:187], v220, s[8:11], s94 offen
	s_waitcnt lgkmcnt(6)
	v_mfma_f32_32x32x16_bf16 v[20:35], v[160:163], v[76:79], v[20:35]
	ds_read_b64_tr_b16 v[176:177], v219 offset:36864
	ds_read_b64_tr_b16 v[178:179], v219 offset:37888
	buffer_load_dwordx4 v[48:51], v2, s[16:19], s80 offen offset:3072
	v_rcp_f32 v211, v211
	v_fmac_f32 v132, v132, v208
	v_fmac_f32 v133, v133, v209
	v_fmac_f32 v134, v134, v210
	v_fmac_f32 v135, v135, v211
	v_cvt_pk_bf16_f32 v192, v132, v133
	v_mul_u32_u24 v224, 272, v227
	v_lshl_add_u32 v224, v226, 5, v224
	s_and_b32 s83, s24, 3
	s_lshl_b32 s83, s83, 3
	s_waitcnt lgkmcnt(6)
	v_mfma_f32_32x32x16_bf16 v[4:19], v[164:167], v[80:83], v[4:19]
	ds_read_b64_tr_b16 v[148:149], v218 offset:38912
	ds_read_b64_tr_b16 v[150:151], v218 offset:39936
	v_cvt_pk_bf16_f32 v193, v134, v135
	v_mul_f32 v136, v136, v222
	v_mul_f32 v137, v137, v222
	v_mul_f32 v138, v138, v222
	v_mul_f32 v139, v139, v222
	v_exp_f32 v208, v136
	v_add_u32 v225, s83, v225
	v_min_u32 v225, 27, v225
	s_lshr_b32 s83, s24, 2
	s_mul_i32 s83, s83, 28
	s_waitcnt lgkmcnt(6)
	v_mfma_f32_32x32x16_bf16 v[20:35], v[168:171], v[80:83], v[20:35]
	ds_read_b64_tr_b16 v[152:153], v219 offset:38912
	ds_read_b64_tr_b16 v[154:155], v219 offset:39936
	v_exp_f32 v209, v137
	v_exp_f32 v210, v138
	v_exp_f32 v211, v139
	v_fma_f32 v212, v208, -0.5, -1.0
	v_add_u32 v225, s83, v225
	v_lshrrev_b32 v227, 2, v0
	v_and_b32 v227, 4, v227
	s_barrier
	s_waitcnt lgkmcnt(6)
	v_mfma_f32_32x32x16_bf16 v[4:19], v[172:175], v[84:87], v[4:19]
	v_add_u32 v218, 0x10000, v218
	v_add_u32 v219, 0x10000, v219
	ds_read_b64_tr_b16 v[156:157], v218 offset:0
	ds_read_b64_tr_b16 v[158:159], v218 offset:1024
	s_add_u32 m0, s30, 98304
	s_add_u32 s81, s5, 114688
	buffer_load_dwordx4 v1, s[68:71], s81 offen lds
	v_fma_f32 v213, v209, -0.5, -1.0
	v_fma_f32 v214, v210, -0.5, -1.0
	v_fma_f32 v215, v211, -0.5, -1.0
	v_fma_f32 v208, v208, v212, -1.0
	v_fma_f32 v209, v209, v213, -1.0
	v_fma_f32 v210, v210, v214, -1.0
	v_fma_f32 v211, v211, v215, -1.0
	v_xor_b32 v226, v226, v227
	v_lshlrev_b32 v226, 4, v226
	v_mad_u32_u24 v3, v225, s84, v226
	v_and_b32 v225, 31, v0
	s_waitcnt lgkmcnt(6)
	v_mfma_f32_32x32x16_bf16 v[20:35], v[176:179], v[84:87], v[20:35]
	ds_read_b64_tr_b16 v[160:161], v219 offset:0
	ds_read_b64_tr_b16 v[162:163], v219 offset:1024
	s_add_u32 m0, s30, 106496
	s_add_u32 s81, s5, 516096
	buffer_load_dwordx4 v1, s[68:71], s81 offen lds
	v_rcp_f32 v208, v208
	v_rcp_f32 v209, v209
	v_rcp_f32 v210, v210
	v_rcp_f32 v211, v211
	s_lshl_b32 s83, s55, 5
	v_add_u32 v225, s83, v225
	v_mul_u32_u24 v225, 272, v225
	s_waitcnt lgkmcnt(6)
	v_mfma_f32_32x32x16_bf16 v[4:19], v[148:151], v[88:91], v[4:19]
	ds_read_b64_tr_b16 v[164:165], v218 offset:2048
	ds_read_b64_tr_b16 v[166:167], v218 offset:3072
	s_mov_b64 exec, 0xf
	buffer_load_dword v230, v231, s[16:19], s7 offen offset:2048 sc1
	s_mov_b64 exec, -1
	s_add_u32 m0, s30, 0
	s_add_u32 s81, s5, 344064
	buffer_load_dwordx4 v1, s[68:71], s81 offen lds
	v_fmac_f32 v136, v136, v208
	v_fmac_f32 v137, v137, v209
	v_fmac_f32 v138, v138, v210
	v_fmac_f32 v139, v139, v211
	v_cvt_pk_bf16_f32 v194, v136, v137
	v_cvt_pk_bf16_f32 v195, v138, v139
	buffer_store_dwordx4 v[192:195], v2, s[16:19], s41 offen sc1
	s_mul_i32 s83, s54, 17408
	v_add_u32 v225, s83, v225
	v_lshrrev_b32 v226, 5, v0
	v_lshl_add_u32 v223, v226, 4, v225
	s_waitcnt lgkmcnt(6)
	v_mfma_f32_32x32x16_bf16 v[20:35], v[152:155], v[88:91], v[20:35]
	ds_read_b64_tr_b16 v[168:169], v219 offset:2048
	ds_read_b64_tr_b16 v[170:171], v219 offset:3072
	s_add_u32 m0, s30, 8192
	s_add_u32 s81, s5, 745472
	buffer_load_dwordx4 v1, s[68:71], s81 offen lds
	s_waitcnt vmcnt(15) lgkmcnt(6)
	v_mfma_f32_32x32x16_bf16 v[4:19], v[156:159], v[92:95], v[4:19]
	ds_read_b64_tr_b16 v[172:173], v218 offset:4096
	ds_read_b64_tr_b16 v[174:175], v218 offset:5120
	s_add_u32 m0, s30, 16384
	s_add_u32 s81, s5, 1146880
	buffer_load_dwordx4 v1, s[68:71], s81 offen lds
	s_waitcnt lgkmcnt(6)
	v_mfma_f32_32x32x16_bf16 v[20:35], v[160:163], v[92:95], v[20:35]
	ds_read_b64_tr_b16 v[176:177], v219 offset:4096
	ds_read_b64_tr_b16 v[178:179], v219 offset:5120
	s_add_u32 m0, s30, 24576
	s_add_u32 s81, s5, 1548288
	buffer_load_dwordx4 v1, s[68:71], s81 offen lds
	s_waitcnt vmcnt(16) lgkmcnt(6)
	v_mfma_f32_32x32x16_bf16 v[4:19], v[164:167], v[96:99], v[4:19]
	ds_read_b64_tr_b16 v[148:149], v218 offset:6144
	ds_read_b64_tr_b16 v[150:151], v218 offset:7168
	s_waitcnt lgkmcnt(6)
	v_mfma_f32_32x32x16_bf16 v[20:35], v[168:171], v[96:99], v[20:35]
	ds_read_b64_tr_b16 v[152:153], v219 offset:6144
	ds_read_b64_tr_b16 v[154:155], v219 offset:7168
	s_barrier
	s_waitcnt vmcnt(15) lgkmcnt(6)
	v_mfma_f32_32x32x16_bf16 v[4:19], v[172:175], v[100:103], v[4:19]
	v_add_u32 v218, 0x10000, v218
	v_add_u32 v219, 0x10000, v219
	ds_read_b64_tr_b16 v[156:157], v218 offset:0
	ds_read_b64_tr_b16 v[158:159], v218 offset:1024
	s_add_u32 m0, s30, 32768
	s_add_u32 s81, s5, 172032
	buffer_load_dwordx4 v1, s[68:71], s81 offen lds
	s_add_u32 m0, s30, 40960
	s_add_u32 s81, s5, 573440
	buffer_load_dwordx4 v1, s[68:71], s81 offen lds
	s_add_u32 m0, s30, 49152
	s_add_u32 s81, s5, 974848
	buffer_load_dwordx4 v1, s[68:71], s81 offen lds
	s_add_u32 m0, s30, 57344
	s_add_u32 s81, s5, 1376256
	buffer_load_dwordx4 v1, s[68:71], s81 offen lds
	s_waitcnt vmcnt(7)
	s_add_u32 s53, s100, 3
	v_mov_b32 v228, s53
	s_mov_b32 exec_hi, 0
	buffer_store_dword v228, v232, s[16:19], s101 offen sc1
	s_mov_b64 exec, -1
	s_waitcnt lgkmcnt(6)
	v_mfma_f32_32x32x16_bf16 v[20:35], v[176:179], v[100:103], v[20:35]
	ds_read_b64_tr_b16 v[160:161], v219 offset:0
	ds_read_b64_tr_b16 v[162:163], v219 offset:1024
	s_nop 9
	s_mov_b32 s53, 0
	s_add_u32 s35, s100, 2
parallel_sum__linear_kernel_hedgehog__dense_activation_mish__prompt_kernel_pl23:
	v_subrev_u32 v228, s35, v230
	v_cmp_gt_u32 vcc, 5, v228
	s_nop 3
	s_and_b32 s34, vcc_lo, 15
	s_cmp_eq_u32 s34, 15
	s_cbranch_scc1 parallel_sum__linear_kernel_hedgehog__dense_activation_mish__prompt_kernel_pk24
	s_mov_b64 exec, 0xf
	buffer_load_dword v230, v231, s[16:19], s7 offen offset:2048 sc1
	s_mov_b64 exec, -1
	s_add_u32 s53, s53, 1
	s_waitcnt vmcnt(0)
	s_cmp_lt_u32 s53, 0x1000
	s_cbranch_scc1 parallel_sum__linear_kernel_hedgehog__dense_activation_mish__prompt_kernel_pl23
parallel_sum__linear_kernel_hedgehog__dense_activation_mish__prompt_kernel_pk24:
	s_nop 1
	s_add_u32 s82, s88, 8192
	buffer_load_dwordx4 v[52:55], v2, s[16:19], s82 offen offset:0
	s_waitcnt lgkmcnt(6)
	v_mfma_f32_32x32x16_bf16 v[4:19], v[148:151], v[104:107], v[4:19]
	ds_read_b64_tr_b16 v[164:165], v218 offset:2048
	ds_read_b64_tr_b16 v[166:167], v218 offset:3072
	buffer_load_dwordx4 v[56:59], v2, s[16:19], s82 offen offset:1024
	s_waitcnt lgkmcnt(6)
	v_mfma_f32_32x32x16_bf16 v[20:35], v[152:155], v[104:107], v[20:35]
	ds_read_b64_tr_b16 v[168:169], v219 offset:2048
	ds_read_b64_tr_b16 v[170:171], v219 offset:3072
	buffer_load_dwordx4 v[108:111], v2, s[16:19], s82 offen offset:2048
	s_mov_b64 exec, 0xf
	buffer_load_dword v230, v231, s[16:19], s7 offen offset:2048 sc1
	s_mov_b64 exec, -1
	s_waitcnt lgkmcnt(6)
	v_mfma_f32_32x32x16_bf16 v[4:19], v[156:159], v[36:39], v[4:19]
	ds_read_b64_tr_b16 v[172:173], v218 offset:4096
	ds_read_b64_tr_b16 v[174:175], v218 offset:5120
	buffer_load_dwordx4 v[112:115], v2, s[16:19], s82 offen offset:3072
	s_waitcnt lgkmcnt(6)
	v_mfma_f32_32x32x16_bf16 v[20:35], v[160:163], v[36:39], v[20:35]
	ds_read_b64_tr_b16 v[176:177], v219 offset:4096
	ds_read_b64_tr_b16 v[178:179], v219 offset:5120
	s_add_u32 s80, s88, 24576
	buffer_load_dwordx4 v[116:119], v2, s[16:19], s80 offen offset:0
	s_waitcnt lgkmcnt(6)
	v_mfma_f32_32x32x16_bf16 v[4:19], v[164:167], v[40:43], v[4:19]
	ds_read_b64_tr_b16 v[148:149], v218 offset:6144
	ds_read_b64_tr_b16 v[150:151], v218 offset:7168
	buffer_load_dwordx4 v[120:123], v2, s[16:19], s80 offen offset:1024
	s_waitcnt lgkmcnt(6)
	v_mfma_f32_32x32x16_bf16 v[20:35], v[168:171], v[40:43], v[20:35]
	ds_read_b64_tr_b16 v[152:153], v219 offset:6144
	ds_read_b64_tr_b16 v[154:155], v219 offset:7168
	buffer_load_dwordx4 v[124:127], v2, s[16:19], s80 offen offset:2048
	s_barrier
	s_waitcnt lgkmcnt(6)
	v_mfma_f32_32x32x16_bf16 v[4:19], v[172:175], v[44:47], v[4:19]
	v_add_u32 v218, 0xffff8000, v218
	v_add_u32 v219, 0xffff8000, v219
	ds_read_b64_tr_b16 v[156:157], v218 offset:0
	ds_read_b64_tr_b16 v[158:159], v218 offset:1024
	buffer_load_dwordx4 v[128:131], v2, s[16:19], s80 offen offset:3072
	s_add_u32 m0, s30, 65536
	s_nop 0
	buffer_load_dwordx4 v3, s[72:75], s5 offen lds
	s_add_u32 m0, s30, 73728
	s_add_u32 s81, s5, 100352
	buffer_load_dwordx4 v3, s[72:75], s81 offen lds
	s_add_u32 m0, s30, 81920
	s_add_u32 s81, s5, 200704
	buffer_load_dwordx4 v3, s[72:75], s81 offen lds
	s_add_u32 m0, s30, 90112
	s_add_u32 s81, s5, 301056
	buffer_load_dwordx4 v3, s[72:75], s81 offen lds
	s_waitcnt lgkmcnt(6)
	v_mfma_f32_32x32x16_bf16 v[20:35], v[176:179], v[44:47], v[20:35]
	ds_read_b64_tr_b16 v[160:161], v219 offset:0
	ds_read_b64_tr_b16 v[162:163], v219 offset:1024
	s_waitcnt vmcnt(9)
	s_nop 8
	s_mov_b32 s53, 0
	s_add_u32 s35, s100, 3
parallel_sum__linear_kernel_hedgehog__dense_activation_mish__prompt_kernel_pl25:
	v_subrev_u32 v228, s35, v230
	v_cmp_gt_u32 vcc, 4, v228
	s_nop 3
	s_and_b32 s34, vcc_lo, 15
	s_cmp_eq_u32 s34, 15
	s_cbranch_scc1 parallel_sum__linear_kernel_hedgehog__dense_activation_mish__prompt_kernel_pk26
	s_mov_b64 exec, 0xf
	buffer_load_dword v230, v231, s[16:19], s7 offen offset:2048 sc1
	s_mov_b64 exec, -1
	s_add_u32 s53, s53, 1
	s_waitcnt vmcnt(0)
	s_cmp_lt_u32 s53, 0x1000
	s_cbranch_scc1 parallel_sum__linear_kernel_hedgehog__dense_activation_mish__prompt_kernel_pl25
parallel_sum__linear_kernel_hedgehog__dense_activation_mish__prompt_kernel_pk26:
	s_nop 1
	s_add_u32 s82, s88, 12288
	buffer_load_dwordx4 v[132:135], v2, s[16:19], s82 offen offset:0
	s_waitcnt lgkmcnt(6)
	v_mfma_f32_32x32x16_bf16 v[4:19], v[148:151], v[48:51], v[4:19]
	ds_read_b64_tr_b16 v[164:165], v218 offset:2048
	ds_read_b64_tr_b16 v[166:167], v218 offset:3072
	buffer_load_dwordx4 v[136:139], v2, s[16:19], s82 offen offset:1024
	s_waitcnt lgkmcnt(6)
	v_mfma_f32_32x32x16_bf16 v[20:35], v[152:155], v[48:51], v[20:35]
	ds_read_b64_tr_b16 v[168:169], v219 offset:2048
	ds_read_b64_tr_b16 v[170:171], v219 offset:3072
	buffer_load_dwordx4 v[140:143], v2, s[16:19], s82 offen offset:2048
	s_waitcnt lgkmcnt(6)
	v_mfma_f32_32x32x16_bf16 v[4:19], v[156:159], v[52:55], v[4:19]
	ds_read_b64_tr_b16 v[172:173], v218 offset:4096
	ds_read_b64_tr_b16 v[174:175], v218 offset:5120
	buffer_load_dwordx4 v[144:147], v2, s[16:19], s82 offen offset:3072
	s_waitcnt lgkmcnt(6)
	v_mfma_f32_32x32x16_bf16 v[20:35], v[160:163], v[52:55], v[20:35]
	ds_read_b64_tr_b16 v[176:177], v219 offset:4096
	ds_read_b64_tr_b16 v[178:179], v219 offset:5120
	s_waitcnt lgkmcnt(6)
	v_mfma_f32_32x32x16_bf16 v[4:19], v[164:167], v[56:59], v[4:19]
	ds_read_b64_tr_b16 v[148:149], v218 offset:6144
	ds_read_b64_tr_b16 v[150:151], v218 offset:7168
	s_waitcnt lgkmcnt(6)
	v_mfma_f32_32x32x16_bf16 v[20:35], v[168:171], v[56:59], v[20:35]
	ds_read_b64_tr_b16 v[152:153], v219 offset:6144
	ds_read_b64_tr_b16 v[154:155], v219 offset:7168
	s_barrier
	s_waitcnt lgkmcnt(6)
	v_mfma_f32_32x32x16_bf16 v[4:19], v[172:175], v[108:111], v[4:19]
	v_add_u32 v218, 0xfffe8000, v218
	v_add_u32 v219, 0xfffe8000, v219
	ds_read_b64_tr_b16 v[156:157], v218 offset:0
	ds_read_b64_tr_b16 v[158:159], v218 offset:1024
	s_add_u32 m0, s30, 131072
	s_add_u32 s81, s5, 50176
	buffer_load_dwordx4 v3, s[72:75], s81 offen lds
	s_waitcnt lgkmcnt(6)
	v_mfma_f32_32x32x16_bf16 v[20:35], v[176:179], v[108:111], v[20:35]
	ds_read_b64_tr_b16 v[160:161], v219 offset:0
	ds_read_b64_tr_b16 v[162:163], v219 offset:1024
	s_add_u32 m0, s30, 139264
	s_add_u32 s81, s5, 150528
	buffer_load_dwordx4 v3, s[72:75], s81 offen lds
	s_waitcnt vmcnt(14) lgkmcnt(6)
	v_mfma_f32_32x32x16_bf16 v[4:19], v[148:151], v[112:115], v[4:19]
	ds_read_b64_tr_b16 v[164:165], v218 offset:2048
	ds_read_b64_tr_b16 v[166:167], v218 offset:3072
	s_add_u32 m0, s30, 147456
	s_add_u32 s81, s5, 250880
	buffer_load_dwordx4 v3, s[72:75], s81 offen lds
	s_waitcnt lgkmcnt(6)
	v_mfma_f32_32x32x16_bf16 v[20:35], v[152:155], v[112:115], v[20:35]
	ds_read_b64_tr_b16 v[168:169], v219 offset:2048
	ds_read_b64_tr_b16 v[170:171], v219 offset:3072
	s_add_u32 m0, s30, 155648
	s_add_u32 s81, s5, 351232
	buffer_load_dwordx4 v3, s[72:75], s81 offen lds
	s_waitcnt vmcnt(15) lgkmcnt(6)
	v_mfma_f32_32x32x16_bf16 v[4:19], v[156:159], v[116:119], v[4:19]
	ds_read_b64_tr_b16 v[172:173], v218 offset:4096
	ds_read_b64_tr_b16 v[174:175], v218 offset:5120
	s_waitcnt lgkmcnt(6)
	v_mfma_f32_32x32x16_bf16 v[20:35], v[160:163], v[116:119], v[20:35]
	ds_read_b64_tr_b16 v[176:177], v219 offset:4096
	ds_read_b64_tr_b16 v[178:179], v219 offset:5120
	s_waitcnt vmcnt(14) lgkmcnt(6)
	v_mfma_f32_32x32x16_bf16 v[4:19], v[164:167], v[120:123], v[4:19]
	ds_read_b64_tr_b16 v[148:149], v218 offset:6144
	ds_read_b64_tr_b16 v[150:151], v218 offset:7168
	s_waitcnt lgkmcnt(6)
	v_mfma_f32_32x32x16_bf16 v[20:35], v[168:171], v[120:123], v[20:35]
	ds_read_b64_tr_b16 v[152:153], v219 offset:6144
	ds_read_b64_tr_b16 v[154:155], v219 offset:7168
	s_barrier
	s_waitcnt vmcnt(13) lgkmcnt(6)
	v_mfma_f32_32x32x16_bf16 v[4:19], v[172:175], v[124:127], v[4:19]
	ds_read_b64_tr_b16 v[156:157], v218 offset:32768
	ds_read_b64_tr_b16 v[158:159], v218 offset:33792
	s_waitcnt lgkmcnt(6)
	v_mfma_f32_32x32x16_bf16 v[20:35], v[176:179], v[124:127], v[20:35]
	ds_read_b64_tr_b16 v[160:161], v219 offset:32768
	ds_read_b64_tr_b16 v[162:163], v219 offset:33792
	s_waitcnt vmcnt(12) lgkmcnt(6)
	v_mfma_f32_32x32x16_bf16 v[4:19], v[148:151], v[128:131], v[4:19]
	ds_read_b64_tr_b16 v[164:165], v218 offset:34816
	ds_read_b64_tr_b16 v[166:167], v218 offset:35840
	s_mov_b64 exec, 0xf
	buffer_load_dword v230, v231, s[16:19], s7 offen offset:0 sc1
	s_mov_b64 exec, -1
	s_waitcnt lgkmcnt(6)
	v_mfma_f32_32x32x16_bf16 v[20:35], v[152:155], v[128:131], v[20:35]
	ds_read_b64_tr_b16 v[168:169], v219 offset:34816
	ds_read_b64_tr_b16 v[170:171], v219 offset:35840
	s_waitcnt vmcnt(8) lgkmcnt(6)
	v_mfma_f32_32x32x16_bf16 v[4:19], v[156:159], v[132:135], v[4:19]
	ds_read_b64_tr_b16 v[172:173], v218 offset:36864
	ds_read_b64_tr_b16 v[174:175], v218 offset:37888
	s_waitcnt lgkmcnt(6)
	v_mfma_f32_32x32x16_bf16 v[20:35], v[160:163], v[132:135], v[20:35]
	ds_read_b64_tr_b16 v[176:177], v219 offset:36864
	ds_read_b64_tr_b16 v[178:179], v219 offset:37888
	s_waitcnt vmcnt(7) lgkmcnt(6)
	v_mfma_f32_32x32x16_bf16 v[4:19], v[164:167], v[136:139], v[4:19]
	ds_read_b64_tr_b16 v[148:149], v218 offset:38912
	ds_read_b64_tr_b16 v[150:151], v218 offset:39936
	s_waitcnt lgkmcnt(6)
	v_mfma_f32_32x32x16_bf16 v[20:35], v[168:171], v[136:139], v[20:35]
	ds_read_b64_tr_b16 v[152:153], v219 offset:38912
	ds_read_b64_tr_b16 v[154:155], v219 offset:39936
	s_barrier
	s_waitcnt vmcnt(6) lgkmcnt(6)
	v_mfma_f32_32x32x16_bf16 v[4:19], v[172:175], v[140:143], v[4:19]
	v_add_u32 v218, 0x10000, v218
	v_add_u32 v219, 0x10000, v219
	ds_read_b64_tr_b16 v[156:157], v218 offset:0
	ds_read_b64_tr_b16 v[158:159], v218 offset:1024
	s_waitcnt vmcnt(0)
	s_nop 6
	s_mov_b32 s53, 0
	s_add_u32 s35, s100, 4
parallel_sum__linear_kernel_hedgehog__dense_activation_mish__prompt_kernel_pl27:
	v_subrev_u32 v228, s35, v230
	v_cmp_gt_u32 vcc, 3, v228
	s_nop 3
	s_and_b32 s34, vcc_lo, 15
	s_cmp_eq_u32 s34, 15
	s_cbranch_scc1 parallel_sum__linear_kernel_hedgehog__dense_activation_mish__prompt_kernel_pk28
	s_mov_b64 exec, 0xf
	buffer_load_dword v230, v231, s[16:19], s7 offen offset:0 sc1
	s_mov_b64 exec, -1
	s_add_u32 s53, s53, 1
	s_waitcnt vmcnt(0)
	s_cmp_lt_u32 s53, 0x1000
	s_cbranch_scc1 parallel_sum__linear_kernel_hedgehog__dense_activation_mish__prompt_kernel_pl27
parallel_sum__linear_kernel_hedgehog__dense_activation_mish__prompt_kernel_pk28:
	s_nop 1
	buffer_load_dwordx4 v[60:63], v2, s[16:19], s89 offen offset:0
	buffer_load_dwordx4 v[64:67], v2, s[16:19], s89 offen offset:1024
	buffer_load_dwordx4 v[68:71], v2, s[16:19], s89 offen offset:2048
	buffer_load_dwordx4 v[72:75], v2, s[16:19], s89 offen offset:3072
	s_waitcnt lgkmcnt(6)
	v_mfma_f32_32x32x16_bf16 v[20:35], v[176:179], v[140:143], v[20:35]
	ds_read_b64_tr_b16 v[160:161], v219 offset:0
	ds_read_b64_tr_b16 v[162:163], v219 offset:1024
	s_add_u32 s82, s89, 4096
	buffer_load_dwordx4 v[76:79], v2, s[16:19], s82 offen offset:0
	buffer_load_dwordx4 v[80:83], v2, s[16:19], s82 offen offset:1024
	buffer_load_dwordx4 v[84:87], v2, s[16:19], s82 offen offset:2048
	buffer_load_dwordx4 v[88:91], v2, s[16:19], s82 offen offset:3072
	s_waitcnt lgkmcnt(6)
	v_mfma_f32_32x32x16_bf16 v[4:19], v[148:151], v[144:147], v[4:19]
	ds_read_b64_tr_b16 v[164:165], v218 offset:2048
	ds_read_b64_tr_b16 v[166:167], v218 offset:3072
	s_waitcnt lgkmcnt(6)
	v_mfma_f32_32x32x16_bf16 v[20:35], v[152:155], v[144:147], v[20:35]
	ds_read_b64_tr_b16 v[168:169], v219 offset:2048
	ds_read_b64_tr_b16 v[170:171], v219 offset:3072
	s_waitcnt vmcnt(7) lgkmcnt(6)
	v_mfma_f32_32x32x16_bf16 v[4:19], v[156:159], v[60:63], v[4:19]
	ds_read_b64_tr_b16 v[172:173], v218 offset:4096
	ds_read_b64_tr_b16 v[174:175], v218 offset:5120
	s_waitcnt lgkmcnt(6)
	v_mfma_f32_32x32x16_bf16 v[20:35], v[160:163], v[60:63], v[20:35]
	ds_read_b64_tr_b16 v[176:177], v219 offset:4096
	ds_read_b64_tr_b16 v[178:179], v219 offset:5120
	s_waitcnt vmcnt(6) lgkmcnt(6)
	v_mfma_f32_32x32x16_bf16 v[4:19], v[164:167], v[64:67], v[4:19]
	ds_read_b64_tr_b16 v[148:149], v218 offset:6144
	ds_read_b64_tr_b16 v[150:151], v218 offset:7168
	s_waitcnt lgkmcnt(6)
	v_mfma_f32_32x32x16_bf16 v[20:35], v[168:171], v[64:67], v[20:35]
	ds_read_b64_tr_b16 v[152:153], v219 offset:6144
	ds_read_b64_tr_b16 v[154:155], v219 offset:7168
	s_waitcnt lgkmcnt(0)
	s_barrier
	s_waitcnt vmcnt(5)
	v_mfma_f32_32x32x16_bf16 v[4:19], v[172:175], v[68:71], v[4:19]
	v_add_u32 v218, 0x10000, v218
	v_add_u32 v219, 0x10000, v219
	ds_read_b64_tr_b16 v[156:157], v218 offset:0
	ds_read_b64_tr_b16 v[158:159], v218 offset:1024
	v_mfma_f32_32x32x16_bf16 v[20:35], v[176:179], v[68:71], v[20:35]
	ds_read_b64_tr_b16 v[160:161], v219 offset:0
	ds_read_b64_tr_b16 v[162:163], v219 offset:1024
	s_waitcnt vmcnt(4)
	v_mfma_f32_32x32x16_bf16 v[4:19], v[148:151], v[72:75], v[4:19]
	ds_read_b64_tr_b16 v[164:165], v218 offset:2048
	ds_read_b64_tr_b16 v[166:167], v218 offset:3072
	v_mfma_f32_32x32x16_bf16 v[20:35], v[152:155], v[72:75], v[20:35]
	ds_read_b64_tr_b16 v[168:169], v219 offset:2048
	ds_read_b64_tr_b16 v[170:171], v219 offset:3072
	s_waitcnt vmcnt(3) lgkmcnt(6)
	v_mfma_f32_32x32x16_bf16 v[4:19], v[156:159], v[76:79], v[4:19]
	ds_read_b64_tr_b16 v[172:173], v218 offset:4096
	ds_read_b64_tr_b16 v[174:175], v218 offset:5120
	s_waitcnt lgkmcnt(6)
	v_mfma_f32_32x32x16_bf16 v[20:35], v[160:163], v[76:79], v[20:35]
	ds_read_b64_tr_b16 v[176:177], v219 offset:4096
	ds_read_b64_tr_b16 v[178:179], v219 offset:5120
	s_waitcnt vmcnt(2) lgkmcnt(6)
	v_mfma_f32_32x32x16_bf16 v[4:19], v[164:167], v[80:83], v[4:19]
	ds_read_b64_tr_b16 v[148:149], v218 offset:6144
	ds_read_b64_tr_b16 v[150:151], v218 offset:7168
	s_waitcnt lgkmcnt(6)
	v_mfma_f32_32x32x16_bf16 v[20:35], v[168:171], v[80:83], v[20:35]
	ds_read_b64_tr_b16 v[152:153], v219 offset:6144
	ds_read_b64_tr_b16 v[154:155], v219 offset:7168
	s_waitcnt vmcnt(1) lgkmcnt(6)
	v_mfma_f32_32x32x16_bf16 v[4:19], v[172:175], v[84:87], v[4:19]
	s_waitcnt lgkmcnt(4)
	v_mfma_f32_32x32x16_bf16 v[20:35], v[176:179], v[84:87], v[20:35]
	s_waitcnt vmcnt(0) lgkmcnt(2)
	v_mfma_f32_32x32x16_bf16 v[4:19], v[148:151], v[88:91], v[4:19]
	s_waitcnt lgkmcnt(0)
	v_mfma_f32_32x32x16_bf16 v[20:35], v[152:155], v[88:91], v[20:35]
	s_nop 9
	ds_write_b128 v223, v[4:7] offset:0
	ds_write_b128 v223, v[8:11] offset:32
	ds_write_b128 v223, v[12:15] offset:64
	ds_write_b128 v223, v[16:19] offset:96
	ds_write_b128 v223, v[20:23] offset:128
	ds_write_b128 v223, v[24:27] offset:160
	ds_write_b128 v223, v[28:31] offset:192
	ds_write_b128 v223, v[32:35] offset:224
	s_waitcnt lgkmcnt(0)
	s_barrier
	ds_read_b128 v[148:151], v224 offset:0
	ds_read_b128 v[152:155], v224 offset:16
	ds_read_b128 v[156:159], v224 offset:17408
	ds_read_b128 v[160:163], v224 offset:17424
	ds_read_b128 v[164:167], v224 offset:34816
	ds_read_b128 v[168:171], v224 offset:34832
	ds_read_b128 v[172:175], v224 offset:52224
	ds_read_b128 v[176:179], v224 offset:52240
	v_lshlrev_b32 v4, 16, v184
	v_and_b32 v5, 0xffff0000, v184
	v_lshlrev_b32 v6, 16, v185
	v_and_b32 v7, 0xffff0000, v185
	v_lshlrev_b32 v8, 16, v186
	v_and_b32 v9, 0xffff0000, v186
	v_lshlrev_b32 v10, 16, v187
	v_and_b32 v11, 0xffff0000, v187
	v_mov_b32 v225, 0x3f317218
	s_waitcnt lgkmcnt(5)
	v_add_f32 v148, v148, v156
	v_add_f32 v149, v149, v157
	v_add_f32 v150, v150, v158
	v_add_f32 v151, v151, v159
	s_waitcnt lgkmcnt(4)
	v_add_f32 v152, v152, v160
	v_add_f32 v153, v153, v161
	v_add_f32 v154, v154, v162
	v_add_f32 v155, v155, v163
	s_waitcnt lgkmcnt(1)
	v_add_f32 v164, v164, v172
	v_add_f32 v165, v165, v173
	v_add_f32 v166, v166, v174
	v_add_f32 v167, v167, v175
	s_waitcnt lgkmcnt(0)
	v_add_f32 v168, v168, v176
	v_add_f32 v169, v169, v177
	v_add_f32 v170, v170, v178
	v_add_f32 v171, v171, v179
	v_add_f32 v148, v148, v164
	v_add_f32 v149, v149, v165
	v_add_f32 v150, v150, v166
	v_add_f32 v151, v151, v167
	v_add_f32 v152, v152, v168
	v_add_f32 v153, v153, v169
	v_add_f32 v154, v154, v170
	v_add_f32 v155, v155, v171
	v_fmac_f32 v4, v148, v225
	v_fmac_f32 v5, v149, v225
	v_fmac_f32 v6, v150, v225
	v_fmac_f32 v7, v151, v225
	v_fmac_f32 v8, v152, v225
	v_fmac_f32 v9, v153, v225
	v_fmac_f32 v10, v154, v225
	v_fmac_f32 v11, v155, v225
	v_cvt_pk_bf16_f32 v148, v4, v5
	v_cvt_pk_bf16_f32 v149, v6, v7
	v_cvt_pk_bf16_f32 v150, v8, v9
	v_cvt_pk_bf16_f32 v151, v10, v11
	buffer_store_dwordx4 v[148:151], v220, s[76:79], s94 offen
parallel_sum__linear_kernel_hedgehog__dense_activation_mish__prompt_kernel_end:
parallel_sum__linear_kernel_hedgehog__dense_activation_mish__prompt_kernel_last:
	s_endpgm
.section .rodata,"a"
.p2align 6
.amdhsa_kernel parallel_sum__linear_kernel_hedgehog__dense_activation_mish__prompt_kernel
  .amdhsa_next_free_vgpr 256
  .amdhsa_next_free_sgpr 102
  .amdhsa_accum_offset 256
  .amdhsa_group_segment_fixed_size 0
  .amdhsa_kernarg_size 88
  .amdhsa_user_sgpr_count 2
  .amdhsa_user_sgpr_kernarg_segment_ptr 1
  .amdhsa_system_sgpr_workgroup_id_x 1
.end_amdhsa_kernel
```
